```python
import torch

def _softmax(x, axis=-1):
    return torch.softmax(x, dim=axis)

def _gelu(x):
    return torch.nn.functional.gelu(x, approximate='tanh')

def _silu(x):
    return torch.nn.functional.silu(x)

def _sigmoid(x):
    return torch.sigmoid(x)

def _layernorm(x, axis=-1, eps=1e-05):
    m = x.mean(dim=axis, keepdim=True)
    v = x.var(dim=axis, keepdim=True, unbiased=False)
    return (x - m) / torch.sqrt(v + eps)

def _scatter_add(tgt, idx, src, axis=0):
    return tgt.clone().index_add_(axis, idx, src)

def _segment_sum(src, seg, n):
    out = torch.zeros((n,) + src.shape[1:], dtype=src.dtype)
    return out.index_add_(0, seg, src)

def _pad(x, pw):
    flat = tuple((v for pair in reversed(pw) for v in pair))
    return torch.nn.functional.pad(x, flat)
kernel_name = 'adaLN_cond__mha_block_cached__swiglu_ffn__decode'

def setup_inputs():

    _w = lambda a: (lambda t: t.to(torch.bfloat16) if t.is_floating_point() else t)(torch.as_tensor(a))

    def _A_setup():
        B, Sq, D = (4, 1, 576)
        H, Sk, Dh = (32, 4096, 128)
        return {'x': _w((lambda *s: torch.randn(*s, dtype=torch.bfloat16) * 0.1)(B, Sq, D)), 'k_cache': _w((lambda *s: torch.randn(*s, dtype=torch.bfloat16) * 0.8)(B, H, Sk, Dh)), 'v_cache': _w((lambda *s: torch.randn(*s, dtype=torch.bfloat16) * 1.6)(B, H, Sk, Dh)), 'wq': _w((lambda *s: torch.randn(*s, dtype=torch.bfloat16) * 0.8)(D, H * Dh) * D ** (-0.5)), 'wo': _w((lambda *s: torch.randn(*s, dtype=torch.bfloat16) * 1.6)(H * Dh, D) * (H * Dh) ** (-0.5))}
    _A_in = _A_setup()

    def _B_setup():
        B, S, D, F = (4, 1, 576, 4608)
        return {'x': _w((lambda *s: torch.randn(*s, dtype=torch.bfloat16) * 0.1)(B, S, D)), 'w_gate': _w((lambda *s: torch.randn(*s, dtype=torch.bfloat16) * 0.2)(D, F)), 'w_up': _w((lambda *s: torch.randn(*s, dtype=torch.bfloat16) * 0.2)(D, F)), 'w_down': _w((lambda *s: torch.randn(*s, dtype=torch.bfloat16) * 0.2)(F, D))}
    _B_in = _B_setup()
    return {'A_x': _A_in['x'], 'A_k_cache': _A_in['k_cache'], 'A_v_cache': _A_in['v_cache'], 'A_wq': _A_in['wq'], 'A_wo': _A_in['wo'], 'B_x': _B_in['x'], 'B_w_gate': _B_in['w_gate'], 'B_w_up': _B_in['w_up'], 'B_w_down': _B_in['w_down'], 'c': _w((lambda *s: torch.randn(*s, dtype=torch.bfloat16) * 0.4)(4, 576) * 8.0), 'w_mod': _w((lambda *s: torch.randn(*s, dtype=torch.bfloat16) * 0.4)(576, 6 * 576) * 576 ** (-0.5) * 8.0)}

def reference(A_x, A_k_cache, A_v_cache, A_wq, A_wo, B_x, B_w_gate, B_w_up, B_w_down, c, w_mod):

    def _A_ref(x, k_cache, v_cache, wq, wo):
        B, Sq, D = x.shape
        H, Dh = (32, 128)
        q = (lambda x, *d: x.permute(*d))((x @ wq).reshape(B, Sq, H, Dh), 0, 2, 1, 3)
        scores = torch.einsum('bhqd,bhkd->bhqk', q, k_cache) * Dh ** (-0.5)
        p = _softmax(scores, axis=-1)
        o = torch.einsum('bhqk,bhkd->bhqd', p, v_cache)
        return (lambda x, *d: x.permute(*d))(o, 0, 2, 1, 3).reshape(B, Sq, H * Dh) @ wo

    def _B_ref(x, w_gate, w_up, w_down):
        g = _silu(x @ w_gate)
        u = x @ w_up
        return g * u @ w_down
    x = A_x
    mod = (_silu(c) @ w_mod).reshape(c.shape[0], 6, 1, -1)
    sa, ca, ga, sb, cb, gb = (mod[:, 0].clone(), mod[:, 1].clone(), mod[:, 2].clone(), mod[:, 3].clone(), mod[:, 4].clone(), mod[:, 5].clone())
    h = _layernorm(x, axis=-1) * (1 + ca) + sa
    x = x + ga * _A_ref(h, A_k_cache, A_v_cache, A_wq, A_wo)
    h = _layernorm(x, axis=-1) * (1 + cb) + sb
    x = x + gb * _B_ref(h, B_w_gate, B_w_up, B_w_down)
    return x
```

```asm
; @launch kernel=k1_mod_kernel grid=(108,1,1) block=(256,1,1) lds=49152
; @launch kernel=k2_q_kernel grid=(128,1,1) block=(256,1,1) lds=49152
; @launch kernel=k3_attn_kernel grid=(1024,1,1) block=(256,1,1) lds=8448
; @launch kernel=k4_wo_kernel grid=(64,1,1) block=(288,1,1) lds=40960
; @launch kernel=k4b_red_kernel grid=(4,1,1) block=(576,1,1) lds=0
; @launch kernel=k5_ffn_kernel grid=(144,1,1) block=(288,1,1) lds=86016
; @launch kernel=k6_fin_kernel grid=(8,1,1) block=(288,1,1) lds=0
.amdgcn_target "amdgcn-amd-amdhsa--gfx950"
.text
.globl k1_mod_kernel
.p2align 8
.type k1_mod_kernel,@function
k1_mod_kernel:
    s_load_dwordx2 s[4:5], s[0:1], 72
    s_load_dwordx2 s[6:7], s[0:1], 80
    s_load_dwordx2 s[8:9], s[0:1], 104
    s_cmp_ge_u32 s2, 108
    s_cbranch_scc1 k1_end
    s_and_b32 s24, s2, 3
    s_lshr_b32 s25, s2, 2
    v_and_b32 v1, 15, v0
    v_lshrrev_b32 v2, 4, v0
    v_lshrrev_b32 v5, 6, v0
    v_and_b32 v6, 63, v0
    s_waitcnt lgkmcnt(0)
    s_mov_b32 s12, s6
    s_mov_b32 s13, s7
    s_mov_b32 s14, 3981312
    s_mov_b32 s15, 0x00020000
    v_mul_u32_u24 v7, 576, v5
    v_add_u32 v7, v7, v6
    v_lshlrev_b32 v7, 1, v7
    global_load_ushort v32, v7, s[4:5] offset:0
    global_load_ushort v33, v7, s[4:5] offset:128
    global_load_ushort v34, v7, s[4:5] offset:256
    global_load_ushort v35, v7, s[4:5] offset:384
    global_load_ushort v36, v7, s[4:5] offset:512
    global_load_ushort v37, v7, s[4:5] offset:640
    global_load_ushort v38, v7, s[4:5] offset:768
    global_load_ushort v39, v7, s[4:5] offset:896
    global_load_ushort v40, v7, s[4:5] offset:1024
    s_mov_b32 s27, 6912
    v_mul_lo_u32 v3, v2, s27
    v_lshl_add_u32 v3, v1, 4, v3
    s_mul_i32 s20, s24, 995328
    s_lshl_b32 s21, s25, 8
    s_add_u32 s20, s20, s21
    buffer_load_dwordx4 v[64:67], v3, s[12:15], s20 offen nt
    s_add_u32 s20, s20, 110592
    buffer_load_dwordx4 v[68:71], v3, s[12:15], s20 offen nt
    s_add_u32 s20, s20, 110592
    buffer_load_dwordx4 v[72:75], v3, s[12:15], s20 offen nt
    s_add_u32 s20, s20, 110592
    buffer_load_dwordx4 v[76:79], v3, s[12:15], s20 offen nt
    s_add_u32 s20, s20, 110592
    buffer_load_dwordx4 v[80:83], v3, s[12:15], s20 offen nt
    s_add_u32 s20, s20, 110592
    buffer_load_dwordx4 v[84:87], v3, s[12:15], s20 offen nt
    s_add_u32 s20, s20, 110592
    buffer_load_dwordx4 v[88:91], v3, s[12:15], s20 offen nt
    s_add_u32 s20, s20, 110592
    buffer_load_dwordx4 v[92:95], v3, s[12:15], s20 offen nt
    s_add_u32 s20, s20, 110592
    buffer_load_dwordx4 v[96:99], v3, s[12:15], s20 offen nt
    s_waitcnt vmcnt(9)
    v_lshlrev_b32 v32, 16, v32
    v_mul_f32 v48, 0xbfb8aa3b, v32
    v_exp_f32 v48, v48
    s_nop 0
    v_add_f32 v48, 1.0, v48
    v_rcp_f32 v48, v48
    s_nop 0
    v_mul_f32 v32, v32, v48
    v_lshlrev_b32 v33, 16, v33
    v_mul_f32 v48, 0xbfb8aa3b, v33
    v_exp_f32 v48, v48
    s_nop 0
    v_add_f32 v48, 1.0, v48
    v_rcp_f32 v48, v48
    s_nop 0
    v_mul_f32 v33, v33, v48
    v_lshlrev_b32 v34, 16, v34
    v_mul_f32 v48, 0xbfb8aa3b, v34
    v_exp_f32 v48, v48
    s_nop 0
    v_add_f32 v48, 1.0, v48
    v_rcp_f32 v48, v48
    s_nop 0
    v_mul_f32 v34, v34, v48
    v_lshlrev_b32 v35, 16, v35
    v_mul_f32 v48, 0xbfb8aa3b, v35
    v_exp_f32 v48, v48
    s_nop 0
    v_add_f32 v48, 1.0, v48
    v_rcp_f32 v48, v48
    s_nop 0
    v_mul_f32 v35, v35, v48
    v_lshlrev_b32 v36, 16, v36
    v_mul_f32 v48, 0xbfb8aa3b, v36
    v_exp_f32 v48, v48
    s_nop 0
    v_add_f32 v48, 1.0, v48
    v_rcp_f32 v48, v48
    s_nop 0
    v_mul_f32 v36, v36, v48
    v_lshlrev_b32 v37, 16, v37
    v_mul_f32 v48, 0xbfb8aa3b, v37
    v_exp_f32 v48, v48
    s_nop 0
    v_add_f32 v48, 1.0, v48
    v_rcp_f32 v48, v48
    s_nop 0
    v_mul_f32 v37, v37, v48
    v_lshlrev_b32 v38, 16, v38
    v_mul_f32 v48, 0xbfb8aa3b, v38
    v_exp_f32 v48, v48
    s_nop 0
    v_add_f32 v48, 1.0, v48
    v_rcp_f32 v48, v48
    s_nop 0
    v_mul_f32 v38, v38, v48
    v_lshlrev_b32 v39, 16, v39
    v_mul_f32 v48, 0xbfb8aa3b, v39
    v_exp_f32 v48, v48
    s_nop 0
    v_add_f32 v48, 1.0, v48
    v_rcp_f32 v48, v48
    s_nop 0
    v_mul_f32 v39, v39, v48
    v_lshlrev_b32 v40, 16, v40
    v_mul_f32 v48, 0xbfb8aa3b, v40
    v_exp_f32 v48, v48
    s_nop 0
    v_add_f32 v48, 1.0, v48
    v_rcp_f32 v48, v48
    s_nop 0
    v_mul_f32 v40, v40, v48
    v_lshlrev_b32 v7, 4, v6
    v_lshl_add_u32 v7, v5, 2, v7
    ds_write_b32 v7, v32 offset:0
    ds_write_b32 v7, v33 offset:1024
    ds_write_b32 v7, v34 offset:2048
    ds_write_b32 v7, v35 offset:3072
    ds_write_b32 v7, v36 offset:4096
    ds_write_b32 v7, v37 offset:5120
    ds_write_b32 v7, v38 offset:6144
    ds_write_b32 v7, v39 offset:7168
    ds_write_b32 v7, v40 offset:8192
    s_waitcnt lgkmcnt(0)
    s_barrier
    s_mul_i32 s26, s24, 144*16
    v_lshlrev_b32 v3, 4, v2
    v_add_u32 v3, s26, v3
    ds_read_b128 v[100:103], v3 offset:0
    ds_read_b128 v[104:107], v3 offset:256
    ds_read_b128 v[108:111], v3 offset:512
    ds_read_b128 v[112:115], v3 offset:768
    ds_read_b128 v[116:119], v3 offset:1024
    ds_read_b128 v[120:123], v3 offset:1280
    ds_read_b128 v[124:127], v3 offset:1536
    ds_read_b128 v[128:131], v3 offset:1792
    ds_read_b128 v[132:135], v3 offset:2048
    s_waitcnt lgkmcnt(0)
    s_waitcnt vmcnt(8)
    v_lshlrev_b32 v250, 16, v64
    v_and_b32 v251, 0xffff0000, v64
    v_mul_f32 v200, v100, v250
    v_mul_f32 v201, v100, v251
    v_mul_f32 v208, v101, v250
    v_mul_f32 v209, v101, v251
    v_mul_f32 v216, v102, v250
    v_mul_f32 v217, v102, v251
    v_mul_f32 v224, v103, v250
    v_mul_f32 v225, v103, v251
    v_lshlrev_b32 v250, 16, v65
    v_and_b32 v251, 0xffff0000, v65
    v_mul_f32 v202, v100, v250
    v_mul_f32 v203, v100, v251
    v_mul_f32 v210, v101, v250
    v_mul_f32 v211, v101, v251
    v_mul_f32 v218, v102, v250
    v_mul_f32 v219, v102, v251
    v_mul_f32 v226, v103, v250
    v_mul_f32 v227, v103, v251
    v_lshlrev_b32 v250, 16, v66
    v_and_b32 v251, 0xffff0000, v66
    v_mul_f32 v204, v100, v250
    v_mul_f32 v205, v100, v251
    v_mul_f32 v212, v101, v250
    v_mul_f32 v213, v101, v251
    v_mul_f32 v220, v102, v250
    v_mul_f32 v221, v102, v251
    v_mul_f32 v228, v103, v250
    v_mul_f32 v229, v103, v251
    v_lshlrev_b32 v250, 16, v67
    v_and_b32 v251, 0xffff0000, v67
    v_mul_f32 v206, v100, v250
    v_mul_f32 v207, v100, v251
    v_mul_f32 v214, v101, v250
    v_mul_f32 v215, v101, v251
    v_mul_f32 v222, v102, v250
    v_mul_f32 v223, v102, v251
    v_mul_f32 v230, v103, v250
    v_mul_f32 v231, v103, v251
    s_waitcnt vmcnt(7)
    v_lshlrev_b32 v250, 16, v68
    v_and_b32 v251, 0xffff0000, v68
    v_fmac_f32 v200, v104, v250
    v_fmac_f32 v201, v104, v251
    v_fmac_f32 v208, v105, v250
    v_fmac_f32 v209, v105, v251
    v_fmac_f32 v216, v106, v250
    v_fmac_f32 v217, v106, v251
    v_fmac_f32 v224, v107, v250
    v_fmac_f32 v225, v107, v251
    v_lshlrev_b32 v250, 16, v69
    v_and_b32 v251, 0xffff0000, v69
    v_fmac_f32 v202, v104, v250
    v_fmac_f32 v203, v104, v251
    v_fmac_f32 v210, v105, v250
    v_fmac_f32 v211, v105, v251
    v_fmac_f32 v218, v106, v250
    v_fmac_f32 v219, v106, v251
    v_fmac_f32 v226, v107, v250
    v_fmac_f32 v227, v107, v251
    v_lshlrev_b32 v250, 16, v70
    v_and_b32 v251, 0xffff0000, v70
    v_fmac_f32 v204, v104, v250
    v_fmac_f32 v205, v104, v251
    v_fmac_f32 v212, v105, v250
    v_fmac_f32 v213, v105, v251
    v_fmac_f32 v220, v106, v250
    v_fmac_f32 v221, v106, v251
    v_fmac_f32 v228, v107, v250
    v_fmac_f32 v229, v107, v251
    v_lshlrev_b32 v250, 16, v71
    v_and_b32 v251, 0xffff0000, v71
    v_fmac_f32 v206, v104, v250
    v_fmac_f32 v207, v104, v251
    v_fmac_f32 v214, v105, v250
    v_fmac_f32 v215, v105, v251
    v_fmac_f32 v222, v106, v250
    v_fmac_f32 v223, v106, v251
    v_fmac_f32 v230, v107, v250
    v_fmac_f32 v231, v107, v251
    s_waitcnt vmcnt(6)
    v_lshlrev_b32 v250, 16, v72
    v_and_b32 v251, 0xffff0000, v72
    v_fmac_f32 v200, v108, v250
    v_fmac_f32 v201, v108, v251
    v_fmac_f32 v208, v109, v250
    v_fmac_f32 v209, v109, v251
    v_fmac_f32 v216, v110, v250
    v_fmac_f32 v217, v110, v251
    v_fmac_f32 v224, v111, v250
    v_fmac_f32 v225, v111, v251
    v_lshlrev_b32 v250, 16, v73
    v_and_b32 v251, 0xffff0000, v73
    v_fmac_f32 v202, v108, v250
    v_fmac_f32 v203, v108, v251
    v_fmac_f32 v210, v109, v250
    v_fmac_f32 v211, v109, v251
    v_fmac_f32 v218, v110, v250
    v_fmac_f32 v219, v110, v251
    v_fmac_f32 v226, v111, v250
    v_fmac_f32 v227, v111, v251
    v_lshlrev_b32 v250, 16, v74
    v_and_b32 v251, 0xffff0000, v74
    v_fmac_f32 v204, v108, v250
    v_fmac_f32 v205, v108, v251
    v_fmac_f32 v212, v109, v250
    v_fmac_f32 v213, v109, v251
    v_fmac_f32 v220, v110, v250
    v_fmac_f32 v221, v110, v251
    v_fmac_f32 v228, v111, v250
    v_fmac_f32 v229, v111, v251
    v_lshlrev_b32 v250, 16, v75
    v_and_b32 v251, 0xffff0000, v75
    v_fmac_f32 v206, v108, v250
    v_fmac_f32 v207, v108, v251
    v_fmac_f32 v214, v109, v250
    v_fmac_f32 v215, v109, v251
    v_fmac_f32 v222, v110, v250
    v_fmac_f32 v223, v110, v251
    v_fmac_f32 v230, v111, v250
    v_fmac_f32 v231, v111, v251
    s_waitcnt vmcnt(5)
    v_lshlrev_b32 v250, 16, v76
    v_and_b32 v251, 0xffff0000, v76
    v_fmac_f32 v200, v112, v250
    v_fmac_f32 v201, v112, v251
    v_fmac_f32 v208, v113, v250
    v_fmac_f32 v209, v113, v251
    v_fmac_f32 v216, v114, v250
    v_fmac_f32 v217, v114, v251
    v_fmac_f32 v224, v115, v250
    v_fmac_f32 v225, v115, v251
    v_lshlrev_b32 v250, 16, v77
    v_and_b32 v251, 0xffff0000, v77
    v_fmac_f32 v202, v112, v250
    v_fmac_f32 v203, v112, v251
    v_fmac_f32 v210, v113, v250
    v_fmac_f32 v211, v113, v251
    v_fmac_f32 v218, v114, v250
    v_fmac_f32 v219, v114, v251
    v_fmac_f32 v226, v115, v250
    v_fmac_f32 v227, v115, v251
    v_lshlrev_b32 v250, 16, v78
    v_and_b32 v251, 0xffff0000, v78
    v_fmac_f32 v204, v112, v250
    v_fmac_f32 v205, v112, v251
    v_fmac_f32 v212, v113, v250
    v_fmac_f32 v213, v113, v251
    v_fmac_f32 v220, v114, v250
    v_fmac_f32 v221, v114, v251
    v_fmac_f32 v228, v115, v250
    v_fmac_f32 v229, v115, v251
    v_lshlrev_b32 v250, 16, v79
    v_and_b32 v251, 0xffff0000, v79
    v_fmac_f32 v206, v112, v250
    v_fmac_f32 v207, v112, v251
    v_fmac_f32 v214, v113, v250
    v_fmac_f32 v215, v113, v251
    v_fmac_f32 v222, v114, v250
    v_fmac_f32 v223, v114, v251
    v_fmac_f32 v230, v115, v250
    v_fmac_f32 v231, v115, v251
    s_waitcnt vmcnt(4)
    v_lshlrev_b32 v250, 16, v80
    v_and_b32 v251, 0xffff0000, v80
    v_fmac_f32 v200, v116, v250
    v_fmac_f32 v201, v116, v251
    v_fmac_f32 v208, v117, v250
    v_fmac_f32 v209, v117, v251
    v_fmac_f32 v216, v118, v250
    v_fmac_f32 v217, v118, v251
    v_fmac_f32 v224, v119, v250
    v_fmac_f32 v225, v119, v251
    v_lshlrev_b32 v250, 16, v81
    v_and_b32 v251, 0xffff0000, v81
    v_fmac_f32 v202, v116, v250
    v_fmac_f32 v203, v116, v251
    v_fmac_f32 v210, v117, v250
    v_fmac_f32 v211, v117, v251
    v_fmac_f32 v218, v118, v250
    v_fmac_f32 v219, v118, v251
    v_fmac_f32 v226, v119, v250
    v_fmac_f32 v227, v119, v251
    v_lshlrev_b32 v250, 16, v82
    v_and_b32 v251, 0xffff0000, v82
    v_fmac_f32 v204, v116, v250
    v_fmac_f32 v205, v116, v251
    v_fmac_f32 v212, v117, v250
    v_fmac_f32 v213, v117, v251
    v_fmac_f32 v220, v118, v250
    v_fmac_f32 v221, v118, v251
    v_fmac_f32 v228, v119, v250
    v_fmac_f32 v229, v119, v251
    v_lshlrev_b32 v250, 16, v83
    v_and_b32 v251, 0xffff0000, v83
    v_fmac_f32 v206, v116, v250
    v_fmac_f32 v207, v116, v251
    v_fmac_f32 v214, v117, v250
    v_fmac_f32 v215, v117, v251
    v_fmac_f32 v222, v118, v250
    v_fmac_f32 v223, v118, v251
    v_fmac_f32 v230, v119, v250
    v_fmac_f32 v231, v119, v251
    s_waitcnt vmcnt(3)
    v_lshlrev_b32 v250, 16, v84
    v_and_b32 v251, 0xffff0000, v84
    v_fmac_f32 v200, v120, v250
    v_fmac_f32 v201, v120, v251
    v_fmac_f32 v208, v121, v250
    v_fmac_f32 v209, v121, v251
    v_fmac_f32 v216, v122, v250
    v_fmac_f32 v217, v122, v251
    v_fmac_f32 v224, v123, v250
    v_fmac_f32 v225, v123, v251
    v_lshlrev_b32 v250, 16, v85
    v_and_b32 v251, 0xffff0000, v85
    v_fmac_f32 v202, v120, v250
    v_fmac_f32 v203, v120, v251
    v_fmac_f32 v210, v121, v250
    v_fmac_f32 v211, v121, v251
    v_fmac_f32 v218, v122, v250
    v_fmac_f32 v219, v122, v251
    v_fmac_f32 v226, v123, v250
    v_fmac_f32 v227, v123, v251
    v_lshlrev_b32 v250, 16, v86
    v_and_b32 v251, 0xffff0000, v86
    v_fmac_f32 v204, v120, v250
    v_fmac_f32 v205, v120, v251
    v_fmac_f32 v212, v121, v250
    v_fmac_f32 v213, v121, v251
    v_fmac_f32 v220, v122, v250
    v_fmac_f32 v221, v122, v251
    v_fmac_f32 v228, v123, v250
    v_fmac_f32 v229, v123, v251
    v_lshlrev_b32 v250, 16, v87
    v_and_b32 v251, 0xffff0000, v87
    v_fmac_f32 v206, v120, v250
    v_fmac_f32 v207, v120, v251
    v_fmac_f32 v214, v121, v250
    v_fmac_f32 v215, v121, v251
    v_fmac_f32 v222, v122, v250
    v_fmac_f32 v223, v122, v251
    v_fmac_f32 v230, v123, v250
    v_fmac_f32 v231, v123, v251
    s_waitcnt vmcnt(2)
    v_lshlrev_b32 v250, 16, v88
    v_and_b32 v251, 0xffff0000, v88
    v_fmac_f32 v200, v124, v250
    v_fmac_f32 v201, v124, v251
    v_fmac_f32 v208, v125, v250
    v_fmac_f32 v209, v125, v251
    v_fmac_f32 v216, v126, v250
    v_fmac_f32 v217, v126, v251
    v_fmac_f32 v224, v127, v250
    v_fmac_f32 v225, v127, v251
    v_lshlrev_b32 v250, 16, v89
    v_and_b32 v251, 0xffff0000, v89
    v_fmac_f32 v202, v124, v250
    v_fmac_f32 v203, v124, v251
    v_fmac_f32 v210, v125, v250
    v_fmac_f32 v211, v125, v251
    v_fmac_f32 v218, v126, v250
    v_fmac_f32 v219, v126, v251
    v_fmac_f32 v226, v127, v250
    v_fmac_f32 v227, v127, v251
    v_lshlrev_b32 v250, 16, v90
    v_and_b32 v251, 0xffff0000, v90
    v_fmac_f32 v204, v124, v250
    v_fmac_f32 v205, v124, v251
    v_fmac_f32 v212, v125, v250
    v_fmac_f32 v213, v125, v251
    v_fmac_f32 v220, v126, v250
    v_fmac_f32 v221, v126, v251
    v_fmac_f32 v228, v127, v250
    v_fmac_f32 v229, v127, v251
    v_lshlrev_b32 v250, 16, v91
    v_and_b32 v251, 0xffff0000, v91
    v_fmac_f32 v206, v124, v250
    v_fmac_f32 v207, v124, v251
    v_fmac_f32 v214, v125, v250
    v_fmac_f32 v215, v125, v251
    v_fmac_f32 v222, v126, v250
    v_fmac_f32 v223, v126, v251
    v_fmac_f32 v230, v127, v250
    v_fmac_f32 v231, v127, v251
    s_waitcnt vmcnt(1)
    v_lshlrev_b32 v250, 16, v92
    v_and_b32 v251, 0xffff0000, v92
    v_fmac_f32 v200, v128, v250
    v_fmac_f32 v201, v128, v251
    v_fmac_f32 v208, v129, v250
    v_fmac_f32 v209, v129, v251
    v_fmac_f32 v216, v130, v250
    v_fmac_f32 v217, v130, v251
    v_fmac_f32 v224, v131, v250
    v_fmac_f32 v225, v131, v251
    v_lshlrev_b32 v250, 16, v93
    v_and_b32 v251, 0xffff0000, v93
    v_fmac_f32 v202, v128, v250
    v_fmac_f32 v203, v128, v251
    v_fmac_f32 v210, v129, v250
    v_fmac_f32 v211, v129, v251
    v_fmac_f32 v218, v130, v250
    v_fmac_f32 v219, v130, v251
    v_fmac_f32 v226, v131, v250
    v_fmac_f32 v227, v131, v251
    v_lshlrev_b32 v250, 16, v94
    v_and_b32 v251, 0xffff0000, v94
    v_fmac_f32 v204, v128, v250
    v_fmac_f32 v205, v128, v251
    v_fmac_f32 v212, v129, v250
    v_fmac_f32 v213, v129, v251
    v_fmac_f32 v220, v130, v250
    v_fmac_f32 v221, v130, v251
    v_fmac_f32 v228, v131, v250
    v_fmac_f32 v229, v131, v251
    v_lshlrev_b32 v250, 16, v95
    v_and_b32 v251, 0xffff0000, v95
    v_fmac_f32 v206, v128, v250
    v_fmac_f32 v207, v128, v251
    v_fmac_f32 v214, v129, v250
    v_fmac_f32 v215, v129, v251
    v_fmac_f32 v222, v130, v250
    v_fmac_f32 v223, v130, v251
    v_fmac_f32 v230, v131, v250
    v_fmac_f32 v231, v131, v251
    s_waitcnt vmcnt(0)
    v_lshlrev_b32 v250, 16, v96
    v_and_b32 v251, 0xffff0000, v96
    v_fmac_f32 v200, v132, v250
    v_fmac_f32 v201, v132, v251
    v_fmac_f32 v208, v133, v250
    v_fmac_f32 v209, v133, v251
    v_fmac_f32 v216, v134, v250
    v_fmac_f32 v217, v134, v251
    v_fmac_f32 v224, v135, v250
    v_fmac_f32 v225, v135, v251
    v_lshlrev_b32 v250, 16, v97
    v_and_b32 v251, 0xffff0000, v97
    v_fmac_f32 v202, v132, v250
    v_fmac_f32 v203, v132, v251
    v_fmac_f32 v210, v133, v250
    v_fmac_f32 v211, v133, v251
    v_fmac_f32 v218, v134, v250
    v_fmac_f32 v219, v134, v251
    v_fmac_f32 v226, v135, v250
    v_fmac_f32 v227, v135, v251
    v_lshlrev_b32 v250, 16, v98
    v_and_b32 v251, 0xffff0000, v98
    v_fmac_f32 v204, v132, v250
    v_fmac_f32 v205, v132, v251
    v_fmac_f32 v212, v133, v250
    v_fmac_f32 v213, v133, v251
    v_fmac_f32 v220, v134, v250
    v_fmac_f32 v221, v134, v251
    v_fmac_f32 v228, v135, v250
    v_fmac_f32 v229, v135, v251
    v_lshlrev_b32 v250, 16, v99
    v_and_b32 v251, 0xffff0000, v99
    v_fmac_f32 v206, v132, v250
    v_fmac_f32 v207, v132, v251
    v_fmac_f32 v214, v133, v250
    v_fmac_f32 v215, v133, v251
    v_fmac_f32 v222, v134, v250
    v_fmac_f32 v223, v134, v251
    v_fmac_f32 v230, v135, v250
    v_fmac_f32 v231, v135, v251
    v_lshlrev_b32 v3, 11, v2
    v_lshlrev_b32 v4, 5, v1
    v_add_u32 v3, v3, v4
    ds_write_b128 v3, v[200:203] offset:16384
    ds_write_b128 v3, v[204:207] offset:16400
    ds_write_b128 v3, v[208:211] offset:16896
    ds_write_b128 v3, v[212:215] offset:16912
    ds_write_b128 v3, v[216:219] offset:17408
    ds_write_b128 v3, v[220:223] offset:17424
    ds_write_b128 v3, v[224:227] offset:17920
    ds_write_b128 v3, v[228:231] offset:17936
    s_waitcnt lgkmcnt(0)
    s_barrier
    v_lshlrev_b32 v3, 2, v0
    ds_read_b32 v160, v3 offset:16384
    ds_read_b32 v161, v3 offset:18432
    ds_read_b32 v162, v3 offset:20480
    ds_read_b32 v163, v3 offset:22528
    ds_read_b32 v164, v3 offset:24576
    ds_read_b32 v165, v3 offset:26624
    ds_read_b32 v166, v3 offset:28672
    ds_read_b32 v167, v3 offset:30720
    ds_read_b32 v168, v3 offset:32768
    ds_read_b32 v169, v3 offset:34816
    ds_read_b32 v170, v3 offset:36864
    ds_read_b32 v171, v3 offset:38912
    ds_read_b32 v172, v3 offset:40960
    ds_read_b32 v173, v3 offset:43008
    ds_read_b32 v174, v3 offset:45056
    ds_read_b32 v175, v3 offset:47104
    ds_read_b32 v176, v3 offset:17408
    ds_read_b32 v177, v3 offset:19456
    ds_read_b32 v178, v3 offset:21504
    ds_read_b32 v179, v3 offset:23552
    ds_read_b32 v180, v3 offset:25600
    ds_read_b32 v181, v3 offset:27648
    ds_read_b32 v182, v3 offset:29696
    ds_read_b32 v183, v3 offset:31744
    ds_read_b32 v184, v3 offset:33792
    ds_read_b32 v185, v3 offset:35840
    ds_read_b32 v186, v3 offset:37888
    ds_read_b32 v187, v3 offset:39936
    ds_read_b32 v188, v3 offset:41984
    ds_read_b32 v189, v3 offset:44032
    ds_read_b32 v190, v3 offset:46080
    ds_read_b32 v191, v3 offset:48128
    s_waitcnt lgkmcnt(0)
    v_add_f32 v160, v160, v161
    v_add_f32 v160, v160, v162
    v_add_f32 v160, v160, v163
    v_add_f32 v160, v160, v164
    v_add_f32 v160, v160, v165
    v_add_f32 v160, v160, v166
    v_add_f32 v160, v160, v167
    v_add_f32 v160, v160, v168
    v_add_f32 v160, v160, v169
    v_add_f32 v160, v160, v170
    v_add_f32 v160, v160, v171
    v_add_f32 v160, v160, v172
    v_add_f32 v160, v160, v173
    v_add_f32 v160, v160, v174
    v_add_f32 v160, v160, v175
    v_add_f32 v176, v176, v177
    v_add_f32 v176, v176, v178
    v_add_f32 v176, v176, v179
    v_add_f32 v176, v176, v180
    v_add_f32 v176, v176, v181
    v_add_f32 v176, v176, v182
    v_add_f32 v176, v176, v183
    v_add_f32 v176, v176, v184
    v_add_f32 v176, v176, v185
    v_add_f32 v176, v176, v186
    v_add_f32 v176, v176, v187
    v_add_f32 v176, v176, v188
    v_add_f32 v176, v176, v189
    v_add_f32 v176, v176, v190
    v_add_f32 v176, v176, v191
    v_lshrrev_b32 v4, 7, v0
    v_and_b32 v5, 127, v0
    s_mul_i32 s26, s24, 55296
    s_lshl_b32 s27, s25, 9
    s_add_u32 s26, s26, s27
    s_add_u32 s26, s26, 0
    s_mov_b32 s27, 13824
    v_mul_lo_u32 v4, v4, s27
    v_lshl_add_u32 v4, v5, 2, v4
    v_add_u32 v4, s26, v4
    global_store_dword v4, v160, s[8:9]
    s_mov_b32 s27, 27648
    v_add_u32 v4, s27, v4
    global_store_dword v4, v176, s[8:9]
    s_cmp_lg_u32 s2, 0
    s_cbranch_scc1 k1_end
    s_add_u32 s28, s8, 1114112
    s_addc_u32 s29, s9, 0
    s_mov_b32 s16, s28
    s_mov_b32 s17, s29
    s_mov_b32 s18, 18432
    s_mov_b32 s19, 0x00020000
    v_mov_b32 v8, 0
    v_mov_b32 v9, 0
    v_mov_b32 v10, 0
    v_mov_b32 v11, 0
    v_lshlrev_b32 v7, 4, v0
    buffer_store_dwordx4 v[8:11], v7, s[16:19], 0 offen offset:0
    v_add_u32 v7, 0x1000, v7
    buffer_store_dwordx4 v[8:11], v7, s[16:19], 0 offen offset:0
    v_add_u32 v7, 0x1000, v7
    buffer_store_dwordx4 v[8:11], v7, s[16:19], 0 offen offset:0
    v_add_u32 v7, 0x1000, v7
    buffer_store_dwordx4 v[8:11], v7, s[16:19], 0 offen offset:0
    v_add_u32 v7, 0x1000, v7
    buffer_store_dwordx4 v[8:11], v7, s[16:19], 0 offen offset:0
k1_end:
    s_endpgm
.globl k2_q_kernel
.p2align 8
.type k2_q_kernel,@function
k2_q_kernel:
    s_load_dwordx2 s[4:5], s[0:1], 0
    s_load_dwordx2 s[6:7], s[0:1], 24
    s_load_dwordx2 s[8:9], s[0:1], 104
    s_cmp_ge_u32 s2, 128
    s_cbranch_scc1 k2_end
    s_and_b32 s24, s2, 3
    s_lshr_b32 s25, s2, 2
    v_and_b32 v1, 15, v0
    v_lshrrev_b32 v2, 4, v0
    v_lshrrev_b32 v5, 6, v0
    v_and_b32 v6, 63, v0
    s_waitcnt lgkmcnt(0)
    s_mov_b32 s12, s6
    s_mov_b32 s13, s7
    s_mov_b32 s14, 4718592
    s_mov_b32 s15, 0x00020000
    v_mul_u32_u24 v7, 576, v5
    v_add_u32 v7, v7, v6
    v_lshlrev_b32 v7, 1, v7
    global_load_ushort v32, v7, s[4:5] offset:0
    global_load_ushort v33, v7, s[4:5] offset:128
    global_load_ushort v34, v7, s[4:5] offset:256
    global_load_ushort v35, v7, s[4:5] offset:384
    global_load_ushort v36, v7, s[4:5] offset:512
    global_load_ushort v37, v7, s[4:5] offset:640
    global_load_ushort v38, v7, s[4:5] offset:768
    global_load_ushort v39, v7, s[4:5] offset:896
    global_load_ushort v40, v7, s[4:5] offset:1024
    v_mul_u32_u24 v7, 3456, v5
    v_add_u32 v7, v7, v6
    v_lshlrev_b32 v7, 2, v7
    s_add_u32 s30, s8, 0
    s_addc_u32 s31, s9, 0
    global_load_dword v160, v7, s[30:31]
    s_add_u32 s30, s8, 256
    s_addc_u32 s31, s9, 0
    global_load_dword v161, v7, s[30:31]
    s_add_u32 s30, s8, 512
    s_addc_u32 s31, s9, 0
    global_load_dword v162, v7, s[30:31]
    s_add_u32 s30, s8, 768
    s_addc_u32 s31, s9, 0
    global_load_dword v163, v7, s[30:31]
    s_add_u32 s30, s8, 1024
    s_addc_u32 s31, s9, 0
    global_load_dword v164, v7, s[30:31]
    s_add_u32 s30, s8, 1280
    s_addc_u32 s31, s9, 0
    global_load_dword v165, v7, s[30:31]
    s_add_u32 s30, s8, 1536
    s_addc_u32 s31, s9, 0
    global_load_dword v166, v7, s[30:31]
    s_add_u32 s30, s8, 1792
    s_addc_u32 s31, s9, 0
    global_load_dword v167, v7, s[30:31]
    s_add_u32 s30, s8, 2048
    s_addc_u32 s31, s9, 0
    global_load_dword v168, v7, s[30:31]
    s_add_u32 s30, s8, 55296
    s_addc_u32 s31, s9, 0
    global_load_dword v169, v7, s[30:31]
    s_add_u32 s30, s8, 55552
    s_addc_u32 s31, s9, 0
    global_load_dword v170, v7, s[30:31]
    s_add_u32 s30, s8, 55808
    s_addc_u32 s31, s9, 0
    global_load_dword v171, v7, s[30:31]
    s_add_u32 s30, s8, 56064
    s_addc_u32 s31, s9, 0
    global_load_dword v172, v7, s[30:31]
    s_add_u32 s30, s8, 56320
    s_addc_u32 s31, s9, 0
    global_load_dword v173, v7, s[30:31]
    s_add_u32 s30, s8, 56576
    s_addc_u32 s31, s9, 0
    global_load_dword v174, v7, s[30:31]
    s_add_u32 s30, s8, 56832
    s_addc_u32 s31, s9, 0
    global_load_dword v175, v7, s[30:31]
    s_add_u32 s30, s8, 57088
    s_addc_u32 s31, s9, 0
    global_load_dword v176, v7, s[30:31]
    s_add_u32 s30, s8, 57344
    s_addc_u32 s31, s9, 0
    global_load_dword v177, v7, s[30:31]
    s_add_u32 s30, s8, 110592
    s_addc_u32 s31, s9, 0
    global_load_dword v178, v7, s[30:31]
    s_add_u32 s30, s8, 110848
    s_addc_u32 s31, s9, 0
    global_load_dword v179, v7, s[30:31]
    s_add_u32 s30, s8, 111104
    s_addc_u32 s31, s9, 0
    global_load_dword v180, v7, s[30:31]
    s_add_u32 s30, s8, 111360
    s_addc_u32 s31, s9, 0
    global_load_dword v181, v7, s[30:31]
    s_add_u32 s30, s8, 111616
    s_addc_u32 s31, s9, 0
    global_load_dword v182, v7, s[30:31]
    s_add_u32 s30, s8, 111872
    s_addc_u32 s31, s9, 0
    global_load_dword v183, v7, s[30:31]
    s_add_u32 s30, s8, 112128
    s_addc_u32 s31, s9, 0
    global_load_dword v184, v7, s[30:31]
    s_add_u32 s30, s8, 112384
    s_addc_u32 s31, s9, 0
    global_load_dword v185, v7, s[30:31]
    s_add_u32 s30, s8, 112640
    s_addc_u32 s31, s9, 0
    global_load_dword v186, v7, s[30:31]
    s_add_u32 s30, s8, 165888
    s_addc_u32 s31, s9, 0
    global_load_dword v187, v7, s[30:31]
    s_add_u32 s30, s8, 166144
    s_addc_u32 s31, s9, 0
    global_load_dword v188, v7, s[30:31]
    s_add_u32 s30, s8, 166400
    s_addc_u32 s31, s9, 0
    global_load_dword v189, v7, s[30:31]
    s_add_u32 s30, s8, 166656
    s_addc_u32 s31, s9, 0
    global_load_dword v190, v7, s[30:31]
    s_add_u32 s30, s8, 166912
    s_addc_u32 s31, s9, 0
    global_load_dword v191, v7, s[30:31]
    s_add_u32 s30, s8, 167168
    s_addc_u32 s31, s9, 0
    global_load_dword v192, v7, s[30:31]
    s_add_u32 s30, s8, 167424
    s_addc_u32 s31, s9, 0
    global_load_dword v193, v7, s[30:31]
    s_add_u32 s30, s8, 167680
    s_addc_u32 s31, s9, 0
    global_load_dword v194, v7, s[30:31]
    s_add_u32 s30, s8, 167936
    s_addc_u32 s31, s9, 0
    global_load_dword v195, v7, s[30:31]
    s_add_u32 s30, s8, 2304
    s_addc_u32 s31, s9, 0
    global_load_dword v200, v7, s[30:31]
    s_add_u32 s30, s8, 2560
    s_addc_u32 s31, s9, 0
    global_load_dword v201, v7, s[30:31]
    s_add_u32 s30, s8, 2816
    s_addc_u32 s31, s9, 0
    global_load_dword v202, v7, s[30:31]
    s_add_u32 s30, s8, 3072
    s_addc_u32 s31, s9, 0
    global_load_dword v203, v7, s[30:31]
    s_add_u32 s30, s8, 3328
    s_addc_u32 s31, s9, 0
    global_load_dword v204, v7, s[30:31]
    s_add_u32 s30, s8, 3584
    s_addc_u32 s31, s9, 0
    global_load_dword v205, v7, s[30:31]
    s_add_u32 s30, s8, 3840
    s_addc_u32 s31, s9, 0
    global_load_dword v206, v7, s[30:31]
    s_add_u32 s30, s8, 4096
    s_addc_u32 s31, s9, 0
    global_load_dword v207, v7, s[30:31]
    s_add_u32 s30, s8, 4352
    s_addc_u32 s31, s9, 0
    global_load_dword v208, v7, s[30:31]
    s_add_u32 s30, s8, 57600
    s_addc_u32 s31, s9, 0
    global_load_dword v209, v7, s[30:31]
    s_add_u32 s30, s8, 57856
    s_addc_u32 s31, s9, 0
    global_load_dword v210, v7, s[30:31]
    s_add_u32 s30, s8, 58112
    s_addc_u32 s31, s9, 0
    global_load_dword v211, v7, s[30:31]
    s_add_u32 s30, s8, 58368
    s_addc_u32 s31, s9, 0
    global_load_dword v212, v7, s[30:31]
    s_add_u32 s30, s8, 58624
    s_addc_u32 s31, s9, 0
    global_load_dword v213, v7, s[30:31]
    s_add_u32 s30, s8, 58880
    s_addc_u32 s31, s9, 0
    global_load_dword v214, v7, s[30:31]
    s_add_u32 s30, s8, 59136
    s_addc_u32 s31, s9, 0
    global_load_dword v215, v7, s[30:31]
    s_add_u32 s30, s8, 59392
    s_addc_u32 s31, s9, 0
    global_load_dword v216, v7, s[30:31]
    s_add_u32 s30, s8, 59648
    s_addc_u32 s31, s9, 0
    global_load_dword v217, v7, s[30:31]
    s_add_u32 s30, s8, 112896
    s_addc_u32 s31, s9, 0
    global_load_dword v218, v7, s[30:31]
    s_add_u32 s30, s8, 113152
    s_addc_u32 s31, s9, 0
    global_load_dword v219, v7, s[30:31]
    s_add_u32 s30, s8, 113408
    s_addc_u32 s31, s9, 0
    global_load_dword v220, v7, s[30:31]
    s_add_u32 s30, s8, 113664
    s_addc_u32 s31, s9, 0
    global_load_dword v221, v7, s[30:31]
    s_add_u32 s30, s8, 113920
    s_addc_u32 s31, s9, 0
    global_load_dword v222, v7, s[30:31]
    s_add_u32 s30, s8, 114176
    s_addc_u32 s31, s9, 0
    global_load_dword v223, v7, s[30:31]
    s_add_u32 s30, s8, 114432
    s_addc_u32 s31, s9, 0
    global_load_dword v224, v7, s[30:31]
    s_add_u32 s30, s8, 114688
    s_addc_u32 s31, s9, 0
    global_load_dword v225, v7, s[30:31]
    s_add_u32 s30, s8, 114944
    s_addc_u32 s31, s9, 0
    global_load_dword v226, v7, s[30:31]
    s_add_u32 s30, s8, 168192
    s_addc_u32 s31, s9, 0
    global_load_dword v227, v7, s[30:31]
    s_add_u32 s30, s8, 168448
    s_addc_u32 s31, s9, 0
    global_load_dword v228, v7, s[30:31]
    s_add_u32 s30, s8, 168704
    s_addc_u32 s31, s9, 0
    global_load_dword v229, v7, s[30:31]
    s_add_u32 s30, s8, 168960
    s_addc_u32 s31, s9, 0
    global_load_dword v230, v7, s[30:31]
    s_add_u32 s30, s8, 169216
    s_addc_u32 s31, s9, 0
    global_load_dword v231, v7, s[30:31]
    s_add_u32 s30, s8, 169472
    s_addc_u32 s31, s9, 0
    global_load_dword v232, v7, s[30:31]
    s_add_u32 s30, s8, 169728
    s_addc_u32 s31, s9, 0
    global_load_dword v233, v7, s[30:31]
    s_add_u32 s30, s8, 169984
    s_addc_u32 s31, s9, 0
    global_load_dword v234, v7, s[30:31]
    s_add_u32 s30, s8, 170240
    s_addc_u32 s31, s9, 0
    global_load_dword v235, v7, s[30:31]
    s_mov_b32 s27, 8192
    v_mul_lo_u32 v3, v2, s27
    v_lshl_add_u32 v3, v1, 4, v3
    s_mul_i32 s20, s24, 1179648
    s_lshl_b32 s21, s25, 8
    s_add_u32 s20, s20, s21
    buffer_load_dwordx4 v[64:67], v3, s[12:15], s20 offen nt
    s_add_u32 s20, s20, 131072
    buffer_load_dwordx4 v[68:71], v3, s[12:15], s20 offen nt
    s_add_u32 s20, s20, 131072
    buffer_load_dwordx4 v[72:75], v3, s[12:15], s20 offen nt
    s_add_u32 s20, s20, 131072
    buffer_load_dwordx4 v[76:79], v3, s[12:15], s20 offen nt
    s_add_u32 s20, s20, 131072
    buffer_load_dwordx4 v[80:83], v3, s[12:15], s20 offen nt
    s_add_u32 s20, s20, 131072
    buffer_load_dwordx4 v[84:87], v3, s[12:15], s20 offen nt
    s_add_u32 s20, s20, 131072
    buffer_load_dwordx4 v[88:91], v3, s[12:15], s20 offen nt
    s_add_u32 s20, s20, 131072
    buffer_load_dwordx4 v[92:95], v3, s[12:15], s20 offen nt
    s_add_u32 s20, s20, 131072
    buffer_load_dwordx4 v[96:99], v3, s[12:15], s20 offen nt
    s_waitcnt vmcnt(9)
    v_lshlrev_b32 v32, 16, v32
    v_lshlrev_b32 v33, 16, v33
    v_lshlrev_b32 v34, 16, v34
    v_lshlrev_b32 v35, 16, v35
    v_lshlrev_b32 v36, 16, v36
    v_lshlrev_b32 v37, 16, v37
    v_lshlrev_b32 v38, 16, v38
    v_lshlrev_b32 v39, 16, v39
    v_lshlrev_b32 v40, 16, v40
    v_add_f32 v160, v160, v169
    v_add_f32 v161, v161, v170
    v_add_f32 v162, v162, v171
    v_add_f32 v163, v163, v172
    v_add_f32 v164, v164, v173
    v_add_f32 v165, v165, v174
    v_add_f32 v166, v166, v175
    v_add_f32 v167, v167, v176
    v_add_f32 v168, v168, v177
    v_add_f32 v160, v160, v178
    v_add_f32 v161, v161, v179
    v_add_f32 v162, v162, v180
    v_add_f32 v163, v163, v181
    v_add_f32 v164, v164, v182
    v_add_f32 v165, v165, v183
    v_add_f32 v166, v166, v184
    v_add_f32 v167, v167, v185
    v_add_f32 v168, v168, v186
    v_add_f32 v160, v160, v187
    v_add_f32 v161, v161, v188
    v_add_f32 v162, v162, v189
    v_add_f32 v163, v163, v190
    v_add_f32 v164, v164, v191
    v_add_f32 v165, v165, v192
    v_add_f32 v166, v166, v193
    v_add_f32 v167, v167, v194
    v_add_f32 v168, v168, v195
    v_add_f32 v200, v200, v209
    v_add_f32 v201, v201, v210
    v_add_f32 v202, v202, v211
    v_add_f32 v203, v203, v212
    v_add_f32 v204, v204, v213
    v_add_f32 v205, v205, v214
    v_add_f32 v206, v206, v215
    v_add_f32 v207, v207, v216
    v_add_f32 v208, v208, v217
    v_add_f32 v200, v200, v218
    v_add_f32 v201, v201, v219
    v_add_f32 v202, v202, v220
    v_add_f32 v203, v203, v221
    v_add_f32 v204, v204, v222
    v_add_f32 v205, v205, v223
    v_add_f32 v206, v206, v224
    v_add_f32 v207, v207, v225
    v_add_f32 v208, v208, v226
    v_add_f32 v200, v200, v227
    v_add_f32 v201, v201, v228
    v_add_f32 v202, v202, v229
    v_add_f32 v203, v203, v230
    v_add_f32 v204, v204, v231
    v_add_f32 v205, v205, v232
    v_add_f32 v206, v206, v233
    v_add_f32 v207, v207, v234
    v_add_f32 v208, v208, v235
    v_add_f32 v48, v32, v33
    v_add_f32 v48, v48, v34
    v_add_f32 v48, v48, v35
    v_add_f32 v48, v48, v36
    v_add_f32 v48, v48, v37
    v_add_f32 v48, v48, v38
    v_add_f32 v48, v48, v39
    v_add_f32 v48, v48, v40
    s_nop 1
    v_add_f32_dpp v48, v48, v48 quad_perm:[1,0,3,2] row_mask:0xf bank_mask:0xf
    s_nop 1
    v_add_f32_dpp v48, v48, v48 quad_perm:[2,3,0,1] row_mask:0xf bank_mask:0xf
    s_nop 1
    v_add_f32_dpp v48, v48, v48 row_half_mirror row_mask:0xf bank_mask:0xf
    s_nop 1
    v_add_f32_dpp v48, v48, v48 row_mirror row_mask:0xf bank_mask:0xf
    s_nop 1
    v_readlane_b32 s40, v48, 0
    v_readlane_b32 s41, v48, 16
    v_readlane_b32 s42, v48, 32
    v_readlane_b32 s43, v48, 48
    s_nop 3
    v_mov_b32 v48, s40
    v_add_f32 v48, s41, v48
    v_add_f32 v48, s42, v48
    v_add_f32 v48, s43, v48
    v_mul_f32 v48, 0x3ae38e39, v48
    v_sub_f32 v32, v32, v48
    v_sub_f32 v33, v33, v48
    v_sub_f32 v34, v34, v48
    v_sub_f32 v35, v35, v48
    v_sub_f32 v36, v36, v48
    v_sub_f32 v37, v37, v48
    v_sub_f32 v38, v38, v48
    v_sub_f32 v39, v39, v48
    v_sub_f32 v40, v40, v48
    v_mul_f32 v48, v32, v32
    v_fmac_f32 v48, v33, v33
    v_fmac_f32 v48, v34, v34
    v_fmac_f32 v48, v35, v35
    v_fmac_f32 v48, v36, v36
    v_fmac_f32 v48, v37, v37
    v_fmac_f32 v48, v38, v38
    v_fmac_f32 v48, v39, v39
    v_fmac_f32 v48, v40, v40
    s_nop 1
    v_add_f32_dpp v48, v48, v48 quad_perm:[1,0,3,2] row_mask:0xf bank_mask:0xf
    s_nop 1
    v_add_f32_dpp v48, v48, v48 quad_perm:[2,3,0,1] row_mask:0xf bank_mask:0xf
    s_nop 1
    v_add_f32_dpp v48, v48, v48 row_half_mirror row_mask:0xf bank_mask:0xf
    s_nop 1
    v_add_f32_dpp v48, v48, v48 row_mirror row_mask:0xf bank_mask:0xf
    s_nop 1
    v_readlane_b32 s40, v48, 0
    v_readlane_b32 s41, v48, 16
    v_readlane_b32 s42, v48, 32
    v_readlane_b32 s43, v48, 48
    s_nop 3
    v_mov_b32 v48, s40
    v_add_f32 v48, s41, v48
    v_add_f32 v48, s42, v48
    v_add_f32 v48, s43, v48
    v_mov_b32 v49, 0x3727c5ac
    v_fmac_f32 v49, 0x3ae38e39, v48
    v_rsq_f32 v49, v49
    s_nop 0
    v_mul_f32 v32, v32, v49
    v_mul_f32 v33, v33, v49
    v_mul_f32 v34, v34, v49
    v_mul_f32 v35, v35, v49
    v_mul_f32 v36, v36, v49
    v_mul_f32 v37, v37, v49
    v_mul_f32 v38, v38, v49
    v_mul_f32 v39, v39, v49
    v_mul_f32 v40, v40, v49
    v_add_f32 v200, 1.0, v200
    v_fma_f32 v32, v32, v200, v160
    v_add_f32 v201, 1.0, v201
    v_fma_f32 v33, v33, v201, v161
    v_add_f32 v202, 1.0, v202
    v_fma_f32 v34, v34, v202, v162
    v_add_f32 v203, 1.0, v203
    v_fma_f32 v35, v35, v203, v163
    v_add_f32 v204, 1.0, v204
    v_fma_f32 v36, v36, v204, v164
    v_add_f32 v205, 1.0, v205
    v_fma_f32 v37, v37, v205, v165
    v_add_f32 v206, 1.0, v206
    v_fma_f32 v38, v38, v206, v166
    v_add_f32 v207, 1.0, v207
    v_fma_f32 v39, v39, v207, v167
    v_add_f32 v208, 1.0, v208
    v_fma_f32 v40, v40, v208, v168
    v_lshlrev_b32 v7, 4, v6
    v_lshl_add_u32 v7, v5, 2, v7
    ds_write_b32 v7, v32 offset:0
    ds_write_b32 v7, v33 offset:1024
    ds_write_b32 v7, v34 offset:2048
    ds_write_b32 v7, v35 offset:3072
    ds_write_b32 v7, v36 offset:4096
    ds_write_b32 v7, v37 offset:5120
    ds_write_b32 v7, v38 offset:6144
    ds_write_b32 v7, v39 offset:7168
    ds_write_b32 v7, v40 offset:8192
    s_waitcnt lgkmcnt(0)
    s_barrier
    s_mul_i32 s26, s24, 144*16
    v_lshlrev_b32 v3, 4, v2
    v_add_u32 v3, s26, v3
    ds_read_b128 v[100:103], v3 offset:0
    ds_read_b128 v[104:107], v3 offset:256
    ds_read_b128 v[108:111], v3 offset:512
    ds_read_b128 v[112:115], v3 offset:768
    ds_read_b128 v[116:119], v3 offset:1024
    ds_read_b128 v[120:123], v3 offset:1280
    ds_read_b128 v[124:127], v3 offset:1536
    ds_read_b128 v[128:131], v3 offset:1792
    ds_read_b128 v[132:135], v3 offset:2048
    s_waitcnt lgkmcnt(0)
    s_waitcnt vmcnt(8)
    v_lshlrev_b32 v250, 16, v64
    v_and_b32 v251, 0xffff0000, v64
    v_mul_f32 v200, v100, v250
    v_mul_f32 v201, v100, v251
    v_mul_f32 v208, v101, v250
    v_mul_f32 v209, v101, v251
    v_mul_f32 v216, v102, v250
    v_mul_f32 v217, v102, v251
    v_mul_f32 v224, v103, v250
    v_mul_f32 v225, v103, v251
    v_lshlrev_b32 v250, 16, v65
    v_and_b32 v251, 0xffff0000, v65
    v_mul_f32 v202, v100, v250
    v_mul_f32 v203, v100, v251
    v_mul_f32 v210, v101, v250
    v_mul_f32 v211, v101, v251
    v_mul_f32 v218, v102, v250
    v_mul_f32 v219, v102, v251
    v_mul_f32 v226, v103, v250
    v_mul_f32 v227, v103, v251
    v_lshlrev_b32 v250, 16, v66
    v_and_b32 v251, 0xffff0000, v66
    v_mul_f32 v204, v100, v250
    v_mul_f32 v205, v100, v251
    v_mul_f32 v212, v101, v250
    v_mul_f32 v213, v101, v251
    v_mul_f32 v220, v102, v250
    v_mul_f32 v221, v102, v251
    v_mul_f32 v228, v103, v250
    v_mul_f32 v229, v103, v251
    v_lshlrev_b32 v250, 16, v67
    v_and_b32 v251, 0xffff0000, v67
    v_mul_f32 v206, v100, v250
    v_mul_f32 v207, v100, v251
    v_mul_f32 v214, v101, v250
    v_mul_f32 v215, v101, v251
    v_mul_f32 v222, v102, v250
    v_mul_f32 v223, v102, v251
    v_mul_f32 v230, v103, v250
    v_mul_f32 v231, v103, v251
    s_waitcnt vmcnt(7)
    v_lshlrev_b32 v250, 16, v68
    v_and_b32 v251, 0xffff0000, v68
    v_fmac_f32 v200, v104, v250
    v_fmac_f32 v201, v104, v251
    v_fmac_f32 v208, v105, v250
    v_fmac_f32 v209, v105, v251
    v_fmac_f32 v216, v106, v250
    v_fmac_f32 v217, v106, v251
    v_fmac_f32 v224, v107, v250
    v_fmac_f32 v225, v107, v251
    v_lshlrev_b32 v250, 16, v69
    v_and_b32 v251, 0xffff0000, v69
    v_fmac_f32 v202, v104, v250
    v_fmac_f32 v203, v104, v251
    v_fmac_f32 v210, v105, v250
    v_fmac_f32 v211, v105, v251
    v_fmac_f32 v218, v106, v250
    v_fmac_f32 v219, v106, v251
    v_fmac_f32 v226, v107, v250
    v_fmac_f32 v227, v107, v251
    v_lshlrev_b32 v250, 16, v70
    v_and_b32 v251, 0xffff0000, v70
    v_fmac_f32 v204, v104, v250
    v_fmac_f32 v205, v104, v251
    v_fmac_f32 v212, v105, v250
    v_fmac_f32 v213, v105, v251
    v_fmac_f32 v220, v106, v250
    v_fmac_f32 v221, v106, v251
    v_fmac_f32 v228, v107, v250
    v_fmac_f32 v229, v107, v251
    v_lshlrev_b32 v250, 16, v71
    v_and_b32 v251, 0xffff0000, v71
    v_fmac_f32 v206, v104, v250
    v_fmac_f32 v207, v104, v251
    v_fmac_f32 v214, v105, v250
    v_fmac_f32 v215, v105, v251
    v_fmac_f32 v222, v106, v250
    v_fmac_f32 v223, v106, v251
    v_fmac_f32 v230, v107, v250
    v_fmac_f32 v231, v107, v251
    s_waitcnt vmcnt(6)
    v_lshlrev_b32 v250, 16, v72
    v_and_b32 v251, 0xffff0000, v72
    v_fmac_f32 v200, v108, v250
    v_fmac_f32 v201, v108, v251
    v_fmac_f32 v208, v109, v250
    v_fmac_f32 v209, v109, v251
    v_fmac_f32 v216, v110, v250
    v_fmac_f32 v217, v110, v251
    v_fmac_f32 v224, v111, v250
    v_fmac_f32 v225, v111, v251
    v_lshlrev_b32 v250, 16, v73
    v_and_b32 v251, 0xffff0000, v73
    v_fmac_f32 v202, v108, v250
    v_fmac_f32 v203, v108, v251
    v_fmac_f32 v210, v109, v250
    v_fmac_f32 v211, v109, v251
    v_fmac_f32 v218, v110, v250
    v_fmac_f32 v219, v110, v251
    v_fmac_f32 v226, v111, v250
    v_fmac_f32 v227, v111, v251
    v_lshlrev_b32 v250, 16, v74
    v_and_b32 v251, 0xffff0000, v74
    v_fmac_f32 v204, v108, v250
    v_fmac_f32 v205, v108, v251
    v_fmac_f32 v212, v109, v250
    v_fmac_f32 v213, v109, v251
    v_fmac_f32 v220, v110, v250
    v_fmac_f32 v221, v110, v251
    v_fmac_f32 v228, v111, v250
    v_fmac_f32 v229, v111, v251
    v_lshlrev_b32 v250, 16, v75
    v_and_b32 v251, 0xffff0000, v75
    v_fmac_f32 v206, v108, v250
    v_fmac_f32 v207, v108, v251
    v_fmac_f32 v214, v109, v250
    v_fmac_f32 v215, v109, v251
    v_fmac_f32 v222, v110, v250
    v_fmac_f32 v223, v110, v251
    v_fmac_f32 v230, v111, v250
    v_fmac_f32 v231, v111, v251
    s_waitcnt vmcnt(5)
    v_lshlrev_b32 v250, 16, v76
    v_and_b32 v251, 0xffff0000, v76
    v_fmac_f32 v200, v112, v250
    v_fmac_f32 v201, v112, v251
    v_fmac_f32 v208, v113, v250
    v_fmac_f32 v209, v113, v251
    v_fmac_f32 v216, v114, v250
    v_fmac_f32 v217, v114, v251
    v_fmac_f32 v224, v115, v250
    v_fmac_f32 v225, v115, v251
    v_lshlrev_b32 v250, 16, v77
    v_and_b32 v251, 0xffff0000, v77
    v_fmac_f32 v202, v112, v250
    v_fmac_f32 v203, v112, v251
    v_fmac_f32 v210, v113, v250
    v_fmac_f32 v211, v113, v251
    v_fmac_f32 v218, v114, v250
    v_fmac_f32 v219, v114, v251
    v_fmac_f32 v226, v115, v250
    v_fmac_f32 v227, v115, v251
    v_lshlrev_b32 v250, 16, v78
    v_and_b32 v251, 0xffff0000, v78
    v_fmac_f32 v204, v112, v250
    v_fmac_f32 v205, v112, v251
    v_fmac_f32 v212, v113, v250
    v_fmac_f32 v213, v113, v251
    v_fmac_f32 v220, v114, v250
    v_fmac_f32 v221, v114, v251
    v_fmac_f32 v228, v115, v250
    v_fmac_f32 v229, v115, v251
    v_lshlrev_b32 v250, 16, v79
    v_and_b32 v251, 0xffff0000, v79
    v_fmac_f32 v206, v112, v250
    v_fmac_f32 v207, v112, v251
    v_fmac_f32 v214, v113, v250
    v_fmac_f32 v215, v113, v251
    v_fmac_f32 v222, v114, v250
    v_fmac_f32 v223, v114, v251
    v_fmac_f32 v230, v115, v250
    v_fmac_f32 v231, v115, v251
    s_waitcnt vmcnt(4)
    v_lshlrev_b32 v250, 16, v80
    v_and_b32 v251, 0xffff0000, v80
    v_fmac_f32 v200, v116, v250
    v_fmac_f32 v201, v116, v251
    v_fmac_f32 v208, v117, v250
    v_fmac_f32 v209, v117, v251
    v_fmac_f32 v216, v118, v250
    v_fmac_f32 v217, v118, v251
    v_fmac_f32 v224, v119, v250
    v_fmac_f32 v225, v119, v251
    v_lshlrev_b32 v250, 16, v81
    v_and_b32 v251, 0xffff0000, v81
    v_fmac_f32 v202, v116, v250
    v_fmac_f32 v203, v116, v251
    v_fmac_f32 v210, v117, v250
    v_fmac_f32 v211, v117, v251
    v_fmac_f32 v218, v118, v250
    v_fmac_f32 v219, v118, v251
    v_fmac_f32 v226, v119, v250
    v_fmac_f32 v227, v119, v251
    v_lshlrev_b32 v250, 16, v82
    v_and_b32 v251, 0xffff0000, v82
    v_fmac_f32 v204, v116, v250
    v_fmac_f32 v205, v116, v251
    v_fmac_f32 v212, v117, v250
    v_fmac_f32 v213, v117, v251
    v_fmac_f32 v220, v118, v250
    v_fmac_f32 v221, v118, v251
    v_fmac_f32 v228, v119, v250
    v_fmac_f32 v229, v119, v251
    v_lshlrev_b32 v250, 16, v83
    v_and_b32 v251, 0xffff0000, v83
    v_fmac_f32 v206, v116, v250
    v_fmac_f32 v207, v116, v251
    v_fmac_f32 v214, v117, v250
    v_fmac_f32 v215, v117, v251
    v_fmac_f32 v222, v118, v250
    v_fmac_f32 v223, v118, v251
    v_fmac_f32 v230, v119, v250
    v_fmac_f32 v231, v119, v251
    s_waitcnt vmcnt(3)
    v_lshlrev_b32 v250, 16, v84
    v_and_b32 v251, 0xffff0000, v84
    v_fmac_f32 v200, v120, v250
    v_fmac_f32 v201, v120, v251
    v_fmac_f32 v208, v121, v250
    v_fmac_f32 v209, v121, v251
    v_fmac_f32 v216, v122, v250
    v_fmac_f32 v217, v122, v251
    v_fmac_f32 v224, v123, v250
    v_fmac_f32 v225, v123, v251
    v_lshlrev_b32 v250, 16, v85
    v_and_b32 v251, 0xffff0000, v85
    v_fmac_f32 v202, v120, v250
    v_fmac_f32 v203, v120, v251
    v_fmac_f32 v210, v121, v250
    v_fmac_f32 v211, v121, v251
    v_fmac_f32 v218, v122, v250
    v_fmac_f32 v219, v122, v251
    v_fmac_f32 v226, v123, v250
    v_fmac_f32 v227, v123, v251
    v_lshlrev_b32 v250, 16, v86
    v_and_b32 v251, 0xffff0000, v86
    v_fmac_f32 v204, v120, v250
    v_fmac_f32 v205, v120, v251
    v_fmac_f32 v212, v121, v250
    v_fmac_f32 v213, v121, v251
    v_fmac_f32 v220, v122, v250
    v_fmac_f32 v221, v122, v251
    v_fmac_f32 v228, v123, v250
    v_fmac_f32 v229, v123, v251
    v_lshlrev_b32 v250, 16, v87
    v_and_b32 v251, 0xffff0000, v87
    v_fmac_f32 v206, v120, v250
    v_fmac_f32 v207, v120, v251
    v_fmac_f32 v214, v121, v250
    v_fmac_f32 v215, v121, v251
    v_fmac_f32 v222, v122, v250
    v_fmac_f32 v223, v122, v251
    v_fmac_f32 v230, v123, v250
    v_fmac_f32 v231, v123, v251
    s_waitcnt vmcnt(2)
    v_lshlrev_b32 v250, 16, v88
    v_and_b32 v251, 0xffff0000, v88
    v_fmac_f32 v200, v124, v250
    v_fmac_f32 v201, v124, v251
    v_fmac_f32 v208, v125, v250
    v_fmac_f32 v209, v125, v251
    v_fmac_f32 v216, v126, v250
    v_fmac_f32 v217, v126, v251
    v_fmac_f32 v224, v127, v250
    v_fmac_f32 v225, v127, v251
    v_lshlrev_b32 v250, 16, v89
    v_and_b32 v251, 0xffff0000, v89
    v_fmac_f32 v202, v124, v250
    v_fmac_f32 v203, v124, v251
    v_fmac_f32 v210, v125, v250
    v_fmac_f32 v211, v125, v251
    v_fmac_f32 v218, v126, v250
    v_fmac_f32 v219, v126, v251
    v_fmac_f32 v226, v127, v250
    v_fmac_f32 v227, v127, v251
    v_lshlrev_b32 v250, 16, v90
    v_and_b32 v251, 0xffff0000, v90
    v_fmac_f32 v204, v124, v250
    v_fmac_f32 v205, v124, v251
    v_fmac_f32 v212, v125, v250
    v_fmac_f32 v213, v125, v251
    v_fmac_f32 v220, v126, v250
    v_fmac_f32 v221, v126, v251
    v_fmac_f32 v228, v127, v250
    v_fmac_f32 v229, v127, v251
    v_lshlrev_b32 v250, 16, v91
    v_and_b32 v251, 0xffff0000, v91
    v_fmac_f32 v206, v124, v250
    v_fmac_f32 v207, v124, v251
    v_fmac_f32 v214, v125, v250
    v_fmac_f32 v215, v125, v251
    v_fmac_f32 v222, v126, v250
    v_fmac_f32 v223, v126, v251
    v_fmac_f32 v230, v127, v250
    v_fmac_f32 v231, v127, v251
    s_waitcnt vmcnt(1)
    v_lshlrev_b32 v250, 16, v92
    v_and_b32 v251, 0xffff0000, v92
    v_fmac_f32 v200, v128, v250
    v_fmac_f32 v201, v128, v251
    v_fmac_f32 v208, v129, v250
    v_fmac_f32 v209, v129, v251
    v_fmac_f32 v216, v130, v250
    v_fmac_f32 v217, v130, v251
    v_fmac_f32 v224, v131, v250
    v_fmac_f32 v225, v131, v251
    v_lshlrev_b32 v250, 16, v93
    v_and_b32 v251, 0xffff0000, v93
    v_fmac_f32 v202, v128, v250
    v_fmac_f32 v203, v128, v251
    v_fmac_f32 v210, v129, v250
    v_fmac_f32 v211, v129, v251
    v_fmac_f32 v218, v130, v250
    v_fmac_f32 v219, v130, v251
    v_fmac_f32 v226, v131, v250
    v_fmac_f32 v227, v131, v251
    v_lshlrev_b32 v250, 16, v94
    v_and_b32 v251, 0xffff0000, v94
    v_fmac_f32 v204, v128, v250
    v_fmac_f32 v205, v128, v251
    v_fmac_f32 v212, v129, v250
    v_fmac_f32 v213, v129, v251
    v_fmac_f32 v220, v130, v250
    v_fmac_f32 v221, v130, v251
    v_fmac_f32 v228, v131, v250
    v_fmac_f32 v229, v131, v251
    v_lshlrev_b32 v250, 16, v95
    v_and_b32 v251, 0xffff0000, v95
    v_fmac_f32 v206, v128, v250
    v_fmac_f32 v207, v128, v251
    v_fmac_f32 v214, v129, v250
    v_fmac_f32 v215, v129, v251
    v_fmac_f32 v222, v130, v250
    v_fmac_f32 v223, v130, v251
    v_fmac_f32 v230, v131, v250
    v_fmac_f32 v231, v131, v251
    s_waitcnt vmcnt(0)
    v_lshlrev_b32 v250, 16, v96
    v_and_b32 v251, 0xffff0000, v96
    v_fmac_f32 v200, v132, v250
    v_fmac_f32 v201, v132, v251
    v_fmac_f32 v208, v133, v250
    v_fmac_f32 v209, v133, v251
    v_fmac_f32 v216, v134, v250
    v_fmac_f32 v217, v134, v251
    v_fmac_f32 v224, v135, v250
    v_fmac_f32 v225, v135, v251
    v_lshlrev_b32 v250, 16, v97
    v_and_b32 v251, 0xffff0000, v97
    v_fmac_f32 v202, v132, v250
    v_fmac_f32 v203, v132, v251
    v_fmac_f32 v210, v133, v250
    v_fmac_f32 v211, v133, v251
    v_fmac_f32 v218, v134, v250
    v_fmac_f32 v219, v134, v251
    v_fmac_f32 v226, v135, v250
    v_fmac_f32 v227, v135, v251
    v_lshlrev_b32 v250, 16, v98
    v_and_b32 v251, 0xffff0000, v98
    v_fmac_f32 v204, v132, v250
    v_fmac_f32 v205, v132, v251
    v_fmac_f32 v212, v133, v250
    v_fmac_f32 v213, v133, v251
    v_fmac_f32 v220, v134, v250
    v_fmac_f32 v221, v134, v251
    v_fmac_f32 v228, v135, v250
    v_fmac_f32 v229, v135, v251
    v_lshlrev_b32 v250, 16, v99
    v_and_b32 v251, 0xffff0000, v99
    v_fmac_f32 v206, v132, v250
    v_fmac_f32 v207, v132, v251
    v_fmac_f32 v214, v133, v250
    v_fmac_f32 v215, v133, v251
    v_fmac_f32 v222, v134, v250
    v_fmac_f32 v223, v134, v251
    v_fmac_f32 v230, v135, v250
    v_fmac_f32 v231, v135, v251
    v_lshlrev_b32 v3, 11, v2
    v_lshlrev_b32 v4, 5, v1
    v_add_u32 v3, v3, v4
    ds_write_b128 v3, v[200:203] offset:16384
    ds_write_b128 v3, v[204:207] offset:16400
    ds_write_b128 v3, v[208:211] offset:16896
    ds_write_b128 v3, v[212:215] offset:16912
    ds_write_b128 v3, v[216:219] offset:17408
    ds_write_b128 v3, v[220:223] offset:17424
    ds_write_b128 v3, v[224:227] offset:17920
    ds_write_b128 v3, v[228:231] offset:17936
    s_waitcnt lgkmcnt(0)
    s_barrier
    v_lshlrev_b32 v3, 2, v0
    ds_read_b32 v160, v3 offset:16384
    ds_read_b32 v161, v3 offset:18432
    ds_read_b32 v162, v3 offset:20480
    ds_read_b32 v163, v3 offset:22528
    ds_read_b32 v164, v3 offset:24576
    ds_read_b32 v165, v3 offset:26624
    ds_read_b32 v166, v3 offset:28672
    ds_read_b32 v167, v3 offset:30720
    ds_read_b32 v168, v3 offset:32768
    ds_read_b32 v169, v3 offset:34816
    ds_read_b32 v170, v3 offset:36864
    ds_read_b32 v171, v3 offset:38912
    ds_read_b32 v172, v3 offset:40960
    ds_read_b32 v173, v3 offset:43008
    ds_read_b32 v174, v3 offset:45056
    ds_read_b32 v175, v3 offset:47104
    ds_read_b32 v176, v3 offset:17408
    ds_read_b32 v177, v3 offset:19456
    ds_read_b32 v178, v3 offset:21504
    ds_read_b32 v179, v3 offset:23552
    ds_read_b32 v180, v3 offset:25600
    ds_read_b32 v181, v3 offset:27648
    ds_read_b32 v182, v3 offset:29696
    ds_read_b32 v183, v3 offset:31744
    ds_read_b32 v184, v3 offset:33792
    ds_read_b32 v185, v3 offset:35840
    ds_read_b32 v186, v3 offset:37888
    ds_read_b32 v187, v3 offset:39936
    ds_read_b32 v188, v3 offset:41984
    ds_read_b32 v189, v3 offset:44032
    ds_read_b32 v190, v3 offset:46080
    ds_read_b32 v191, v3 offset:48128
    s_waitcnt lgkmcnt(0)
    v_add_f32 v160, v160, v161
    v_add_f32 v160, v160, v162
    v_add_f32 v160, v160, v163
    v_add_f32 v160, v160, v164
    v_add_f32 v160, v160, v165
    v_add_f32 v160, v160, v166
    v_add_f32 v160, v160, v167
    v_add_f32 v160, v160, v168
    v_add_f32 v160, v160, v169
    v_add_f32 v160, v160, v170
    v_add_f32 v160, v160, v171
    v_add_f32 v160, v160, v172
    v_add_f32 v160, v160, v173
    v_add_f32 v160, v160, v174
    v_add_f32 v160, v160, v175
    v_add_f32 v176, v176, v177
    v_add_f32 v176, v176, v178
    v_add_f32 v176, v176, v179
    v_add_f32 v176, v176, v180
    v_add_f32 v176, v176, v181
    v_add_f32 v176, v176, v182
    v_add_f32 v176, v176, v183
    v_add_f32 v176, v176, v184
    v_add_f32 v176, v176, v185
    v_add_f32 v176, v176, v186
    v_add_f32 v176, v176, v187
    v_add_f32 v176, v176, v188
    v_add_f32 v176, v176, v189
    v_add_f32 v176, v176, v190
    v_add_f32 v176, v176, v191
    v_lshrrev_b32 v4, 7, v0
    v_and_b32 v5, 127, v0
    s_mul_i32 s26, s24, 65536
    s_lshl_b32 s27, s25, 9
    s_add_u32 s26, s26, s27
    s_add_u32 s26, s26, 262144
    s_mov_b32 s27, 16384
    v_mul_lo_u32 v4, v4, s27
    v_lshl_add_u32 v4, v5, 2, v4
    v_add_u32 v4, s26, v4
    global_store_dword v4, v160, s[8:9]
    s_mov_b32 s27, 32768
    v_add_u32 v4, s27, v4
    global_store_dword v4, v176, s[8:9]
k2_end:
    s_endpgm
.globl k3_attn_kernel
.p2align 8
.type k3_attn_kernel,@function
k3_attn_kernel:
    s_load_dwordx2 s[4:5], s[0:1], 8
    s_load_dwordx2 s[6:7], s[0:1], 16
    s_load_dwordx2 s[8:9], s[0:1], 104
    s_cmp_ge_u32 s2, 1024
    s_cbranch_scc1 k3_end
    v_lshrrev_b32 v5, 6, v0
    v_and_b32 v6, 63, v0
    s_nop 0
    v_readfirstlane_b32 s20, v5
    s_lshr_b32 s21, s2, 3
    s_and_b32 s22, s2, 7
    s_lshl_b32 s23, s21, 20
    s_mul_i32 s24, s22, 131072
    s_add_u32 s23, s23, s24
    s_mul_i32 s24, s20, 32768
    s_add_u32 s23, s23, s24
    s_waitcnt lgkmcnt(0)
    s_add_u32 s4, s4, s23
    s_addc_u32 s5, s5, 0
    s_add_u32 s6, s6, s23
    s_addc_u32 s7, s7, 0
    v_lshlrev_b32 v1, 4, v6
    s_lshr_b32 s24, s2, 3
    s_add_u32 s24, s24, s2
    s_add_u32 s24, s24, s20
    s_and_b32 s24, s24, 7
    s_lshl_b32 s24, s24, 12
    v_add_u32 v1, s24, v1
    v_and_b32 v2, 15, v6
    v_lshlrev_b32 v2, 5, v2
    s_lshl_b32 s25, s21, 9
    s_add_u32 s25, s25, 262144
    s_add_u32 s26, s8, s25
    s_addc_u32 s27, s9, 0
    global_load_dwordx4 v[96:99], v2, s[26:27]
    global_load_dwordx4 v[100:103], v2, s[26:27] offset:16
    s_add_u32 s26, s26, 65536
    s_addc_u32 s27, s27, 0
    global_load_dwordx4 v[104:107], v2, s[26:27]
    global_load_dwordx4 v[108:111], v2, s[26:27] offset:16
    s_add_u32 s26, s26, 65536
    s_addc_u32 s27, s27, 0
    global_load_dwordx4 v[112:115], v2, s[26:27]
    global_load_dwordx4 v[116:119], v2, s[26:27] offset:16
    s_add_u32 s26, s26, 65536
    s_addc_u32 s27, s27, 0
    global_load_dwordx4 v[120:123], v2, s[26:27]
    global_load_dwordx4 v[124:127], v2, s[26:27] offset:16
    global_load_dwordx4 v[32:35], v1, s[4:5] offset:0 nt
    global_load_dwordx4 v[36:39], v1, s[4:5] offset:1024 nt
    global_load_dwordx4 v[40:43], v1, s[4:5] offset:2048 nt
    global_load_dwordx4 v[44:47], v1, s[4:5] offset:3072 nt
    global_load_dwordx4 v[64:67], v1, s[6:7] offset:0 nt
    global_load_dwordx4 v[68:71], v1, s[6:7] offset:1024 nt
    global_load_dwordx4 v[72:75], v1, s[6:7] offset:2048 nt
    global_load_dwordx4 v[76:79], v1, s[6:7] offset:3072 nt
    v_add_u32 v1, 0x1000, v1
    v_and_b32 v1, 0x7fff, v1
    global_load_dwordx4 v[48:51], v1, s[4:5] offset:0 nt
    global_load_dwordx4 v[52:55], v1, s[4:5] offset:1024 nt
    global_load_dwordx4 v[56:59], v1, s[4:5] offset:2048 nt
    global_load_dwordx4 v[60:63], v1, s[4:5] offset:3072 nt
    global_load_dwordx4 v[80:83], v1, s[6:7] offset:0 nt
    global_load_dwordx4 v[84:87], v1, s[6:7] offset:1024 nt
    global_load_dwordx4 v[88:91], v1, s[6:7] offset:2048 nt
    global_load_dwordx4 v[92:95], v1, s[6:7] offset:3072 nt
    v_add_u32 v1, 0x1000, v1
    v_and_b32 v1, 0x7fff, v1
    s_waitcnt vmcnt(16)
    v_add_f32 v8, v96, v104
    v_add_f32 v112, v112, v120
    v_add_f32 v8, v8, v112
    v_mul_f32 v8, 0x3e0293ee, v8
    v_mov_b32 v16, 0
    v_add_f32 v9, v97, v105
    v_add_f32 v113, v113, v121
    v_add_f32 v9, v9, v113
    v_mul_f32 v9, 0x3e0293ee, v9
    v_mov_b32 v17, 0
    v_add_f32 v10, v98, v106
    v_add_f32 v114, v114, v122
    v_add_f32 v10, v10, v114
    v_mul_f32 v10, 0x3e0293ee, v10
    v_mov_b32 v18, 0
    v_add_f32 v11, v99, v107
    v_add_f32 v115, v115, v123
    v_add_f32 v11, v11, v115
    v_mul_f32 v11, 0x3e0293ee, v11
    v_mov_b32 v19, 0
    v_add_f32 v12, v100, v108
    v_add_f32 v116, v116, v124
    v_add_f32 v12, v12, v116
    v_mul_f32 v12, 0x3e0293ee, v12
    v_mov_b32 v20, 0
    v_add_f32 v13, v101, v109
    v_add_f32 v117, v117, v125
    v_add_f32 v13, v13, v117
    v_mul_f32 v13, 0x3e0293ee, v13
    v_mov_b32 v21, 0
    v_add_f32 v14, v102, v110
    v_add_f32 v118, v118, v126
    v_add_f32 v14, v14, v118
    v_mul_f32 v14, 0x3e0293ee, v14
    v_mov_b32 v22, 0
    v_add_f32 v15, v103, v111
    v_add_f32 v119, v119, v127
    v_add_f32 v15, v15, v119
    v_mul_f32 v15, 0x3e0293ee, v15
    v_mov_b32 v23, 0
    v_mov_b32 v24, 0xff800000
    v_mov_b32 v25, 0
    s_waitcnt vmcnt(12)
    v_lshlrev_b32 v100, 16, v32
    v_mul_f32 v96, v8, v100
    v_lshlrev_b32 v101, 16, v36
    v_mul_f32 v97, v8, v101
    v_lshlrev_b32 v102, 16, v40
    v_mul_f32 v98, v8, v102
    v_lshlrev_b32 v103, 16, v44
    v_mul_f32 v99, v8, v103
    v_and_b32 v100, 0xffff0000, v32
    v_fmac_f32 v96, v9, v100
    v_and_b32 v101, 0xffff0000, v36
    v_fmac_f32 v97, v9, v101
    v_and_b32 v102, 0xffff0000, v40
    v_fmac_f32 v98, v9, v102
    v_and_b32 v103, 0xffff0000, v44
    v_fmac_f32 v99, v9, v103
    v_lshlrev_b32 v100, 16, v33
    v_fmac_f32 v96, v10, v100
    v_lshlrev_b32 v101, 16, v37
    v_fmac_f32 v97, v10, v101
    v_lshlrev_b32 v102, 16, v41
    v_fmac_f32 v98, v10, v102
    v_lshlrev_b32 v103, 16, v45
    v_fmac_f32 v99, v10, v103
    v_and_b32 v100, 0xffff0000, v33
    v_fmac_f32 v96, v11, v100
    v_and_b32 v101, 0xffff0000, v37
    v_fmac_f32 v97, v11, v101
    v_and_b32 v102, 0xffff0000, v41
    v_fmac_f32 v98, v11, v102
    v_and_b32 v103, 0xffff0000, v45
    v_fmac_f32 v99, v11, v103
    v_lshlrev_b32 v100, 16, v34
    v_fmac_f32 v96, v12, v100
    v_lshlrev_b32 v101, 16, v38
    v_fmac_f32 v97, v12, v101
    v_lshlrev_b32 v102, 16, v42
    v_fmac_f32 v98, v12, v102
    v_lshlrev_b32 v103, 16, v46
    v_fmac_f32 v99, v12, v103
    v_and_b32 v100, 0xffff0000, v34
    v_fmac_f32 v96, v13, v100
    v_and_b32 v101, 0xffff0000, v38
    v_fmac_f32 v97, v13, v101
    v_and_b32 v102, 0xffff0000, v42
    v_fmac_f32 v98, v13, v102
    v_and_b32 v103, 0xffff0000, v46
    v_fmac_f32 v99, v13, v103
    v_lshlrev_b32 v100, 16, v35
    v_fmac_f32 v96, v14, v100
    v_lshlrev_b32 v101, 16, v39
    v_fmac_f32 v97, v14, v101
    v_lshlrev_b32 v102, 16, v43
    v_fmac_f32 v98, v14, v102
    v_lshlrev_b32 v103, 16, v47
    v_fmac_f32 v99, v14, v103
    v_and_b32 v100, 0xffff0000, v35
    v_fmac_f32 v96, v15, v100
    v_and_b32 v101, 0xffff0000, v39
    v_fmac_f32 v97, v15, v101
    v_and_b32 v102, 0xffff0000, v43
    v_fmac_f32 v98, v15, v102
    v_and_b32 v103, 0xffff0000, v47
    v_fmac_f32 v99, v15, v103
    global_load_dwordx4 v[32:35], v1, s[4:5] offset:0 nt
    global_load_dwordx4 v[36:39], v1, s[4:5] offset:1024 nt
    global_load_dwordx4 v[40:43], v1, s[4:5] offset:2048 nt
    global_load_dwordx4 v[44:47], v1, s[4:5] offset:3072 nt
    v_add_f32_dpp v96, v96, v96 quad_perm:[1,0,3,2] row_mask:0xf bank_mask:0xf
    v_add_f32_dpp v97, v97, v97 quad_perm:[1,0,3,2] row_mask:0xf bank_mask:0xf
    v_add_f32_dpp v98, v98, v98 quad_perm:[1,0,3,2] row_mask:0xf bank_mask:0xf
    v_add_f32_dpp v99, v99, v99 quad_perm:[1,0,3,2] row_mask:0xf bank_mask:0xf
    v_add_f32_dpp v96, v96, v96 quad_perm:[2,3,0,1] row_mask:0xf bank_mask:0xf
    v_add_f32_dpp v97, v97, v97 quad_perm:[2,3,0,1] row_mask:0xf bank_mask:0xf
    v_add_f32_dpp v98, v98, v98 quad_perm:[2,3,0,1] row_mask:0xf bank_mask:0xf
    v_add_f32_dpp v99, v99, v99 quad_perm:[2,3,0,1] row_mask:0xf bank_mask:0xf
    v_add_f32_dpp v96, v96, v96 row_half_mirror row_mask:0xf bank_mask:0xf
    v_add_f32_dpp v97, v97, v97 row_half_mirror row_mask:0xf bank_mask:0xf
    v_add_f32_dpp v98, v98, v98 row_half_mirror row_mask:0xf bank_mask:0xf
    v_add_f32_dpp v99, v99, v99 row_half_mirror row_mask:0xf bank_mask:0xf
    v_add_f32_dpp v96, v96, v96 row_mirror row_mask:0xf bank_mask:0xf
    v_add_f32_dpp v97, v97, v97 row_mirror row_mask:0xf bank_mask:0xf
    v_add_f32_dpp v98, v98, v98 row_mirror row_mask:0xf bank_mask:0xf
    v_add_f32_dpp v99, v99, v99 row_mirror row_mask:0xf bank_mask:0xf
    v_max3_f32 v104, v96, v97, v24
    v_max3_f32 v104, v98, v99, v104
    v_sub_f32 v105, v24, v104
    v_exp_f32 v105, v105
    v_sub_f32 v96, v96, v104
    v_sub_f32 v97, v97, v104
    v_sub_f32 v98, v98, v104
    v_sub_f32 v99, v99, v104
    v_exp_f32 v96, v96
    v_exp_f32 v97, v97
    v_exp_f32 v98, v98
    v_exp_f32 v99, v99
    v_mov_b32 v24, v104
    v_mul_f32 v25, v25, v105
    v_mul_f32 v16, v16, v105
    v_mul_f32 v17, v17, v105
    v_mul_f32 v18, v18, v105
    v_mul_f32 v19, v19, v105
    v_mul_f32 v20, v20, v105
    v_mul_f32 v21, v21, v105
    v_mul_f32 v22, v22, v105
    v_mul_f32 v23, v23, v105
    v_add_f32 v25, v25, v96
    v_add_f32 v25, v25, v97
    v_add_f32 v25, v25, v98
    v_add_f32 v25, v25, v99
    s_waitcnt vmcnt(12)
    v_lshlrev_b32 v100, 16, v64
    v_fmac_f32 v16, v96, v100
    v_and_b32 v101, 0xffff0000, v64
    v_fmac_f32 v17, v96, v101
    v_lshlrev_b32 v102, 16, v65
    v_fmac_f32 v18, v96, v102
    v_and_b32 v103, 0xffff0000, v65
    v_fmac_f32 v19, v96, v103
    v_lshlrev_b32 v100, 16, v66
    v_fmac_f32 v20, v96, v100
    v_and_b32 v101, 0xffff0000, v66
    v_fmac_f32 v21, v96, v101
    v_lshlrev_b32 v102, 16, v67
    v_fmac_f32 v22, v96, v102
    v_and_b32 v103, 0xffff0000, v67
    v_fmac_f32 v23, v96, v103
    v_lshlrev_b32 v100, 16, v68
    v_fmac_f32 v16, v97, v100
    v_and_b32 v101, 0xffff0000, v68
    v_fmac_f32 v17, v97, v101
    v_lshlrev_b32 v102, 16, v69
    v_fmac_f32 v18, v97, v102
    v_and_b32 v103, 0xffff0000, v69
    v_fmac_f32 v19, v97, v103
    v_lshlrev_b32 v100, 16, v70
    v_fmac_f32 v20, v97, v100
    v_and_b32 v101, 0xffff0000, v70
    v_fmac_f32 v21, v97, v101
    v_lshlrev_b32 v102, 16, v71
    v_fmac_f32 v22, v97, v102
    v_and_b32 v103, 0xffff0000, v71
    v_fmac_f32 v23, v97, v103
    v_lshlrev_b32 v100, 16, v72
    v_fmac_f32 v16, v98, v100
    v_and_b32 v101, 0xffff0000, v72
    v_fmac_f32 v17, v98, v101
    v_lshlrev_b32 v102, 16, v73
    v_fmac_f32 v18, v98, v102
    v_and_b32 v103, 0xffff0000, v73
    v_fmac_f32 v19, v98, v103
    v_lshlrev_b32 v100, 16, v74
    v_fmac_f32 v20, v98, v100
    v_and_b32 v101, 0xffff0000, v74
    v_fmac_f32 v21, v98, v101
    v_lshlrev_b32 v102, 16, v75
    v_fmac_f32 v22, v98, v102
    v_and_b32 v103, 0xffff0000, v75
    v_fmac_f32 v23, v98, v103
    v_lshlrev_b32 v100, 16, v76
    v_fmac_f32 v16, v99, v100
    v_and_b32 v101, 0xffff0000, v76
    v_fmac_f32 v17, v99, v101
    v_lshlrev_b32 v102, 16, v77
    v_fmac_f32 v18, v99, v102
    v_and_b32 v103, 0xffff0000, v77
    v_fmac_f32 v19, v99, v103
    v_lshlrev_b32 v100, 16, v78
    v_fmac_f32 v20, v99, v100
    v_and_b32 v101, 0xffff0000, v78
    v_fmac_f32 v21, v99, v101
    v_lshlrev_b32 v102, 16, v79
    v_fmac_f32 v22, v99, v102
    v_and_b32 v103, 0xffff0000, v79
    v_fmac_f32 v23, v99, v103
    global_load_dwordx4 v[64:67], v1, s[6:7] offset:0 nt
    global_load_dwordx4 v[68:71], v1, s[6:7] offset:1024 nt
    global_load_dwordx4 v[72:75], v1, s[6:7] offset:2048 nt
    global_load_dwordx4 v[76:79], v1, s[6:7] offset:3072 nt
    v_add_u32 v1, 0x1000, v1
    v_and_b32 v1, 0x7fff, v1
    s_waitcnt vmcnt(12)
    v_lshlrev_b32 v100, 16, v48
    v_mul_f32 v96, v8, v100
    v_lshlrev_b32 v101, 16, v52
    v_mul_f32 v97, v8, v101
    v_lshlrev_b32 v102, 16, v56
    v_mul_f32 v98, v8, v102
    v_lshlrev_b32 v103, 16, v60
    v_mul_f32 v99, v8, v103
    v_and_b32 v100, 0xffff0000, v48
    v_fmac_f32 v96, v9, v100
    v_and_b32 v101, 0xffff0000, v52
    v_fmac_f32 v97, v9, v101
    v_and_b32 v102, 0xffff0000, v56
    v_fmac_f32 v98, v9, v102
    v_and_b32 v103, 0xffff0000, v60
    v_fmac_f32 v99, v9, v103
    v_lshlrev_b32 v100, 16, v49
    v_fmac_f32 v96, v10, v100
    v_lshlrev_b32 v101, 16, v53
    v_fmac_f32 v97, v10, v101
    v_lshlrev_b32 v102, 16, v57
    v_fmac_f32 v98, v10, v102
    v_lshlrev_b32 v103, 16, v61
    v_fmac_f32 v99, v10, v103
    v_and_b32 v100, 0xffff0000, v49
    v_fmac_f32 v96, v11, v100
    v_and_b32 v101, 0xffff0000, v53
    v_fmac_f32 v97, v11, v101
    v_and_b32 v102, 0xffff0000, v57
    v_fmac_f32 v98, v11, v102
    v_and_b32 v103, 0xffff0000, v61
    v_fmac_f32 v99, v11, v103
    v_lshlrev_b32 v100, 16, v50
    v_fmac_f32 v96, v12, v100
    v_lshlrev_b32 v101, 16, v54
    v_fmac_f32 v97, v12, v101
    v_lshlrev_b32 v102, 16, v58
    v_fmac_f32 v98, v12, v102
    v_lshlrev_b32 v103, 16, v62
    v_fmac_f32 v99, v12, v103
    v_and_b32 v100, 0xffff0000, v50
    v_fmac_f32 v96, v13, v100
    v_and_b32 v101, 0xffff0000, v54
    v_fmac_f32 v97, v13, v101
    v_and_b32 v102, 0xffff0000, v58
    v_fmac_f32 v98, v13, v102
    v_and_b32 v103, 0xffff0000, v62
    v_fmac_f32 v99, v13, v103
    v_lshlrev_b32 v100, 16, v51
    v_fmac_f32 v96, v14, v100
    v_lshlrev_b32 v101, 16, v55
    v_fmac_f32 v97, v14, v101
    v_lshlrev_b32 v102, 16, v59
    v_fmac_f32 v98, v14, v102
    v_lshlrev_b32 v103, 16, v63
    v_fmac_f32 v99, v14, v103
    v_and_b32 v100, 0xffff0000, v51
    v_fmac_f32 v96, v15, v100
    v_and_b32 v101, 0xffff0000, v55
    v_fmac_f32 v97, v15, v101
    v_and_b32 v102, 0xffff0000, v59
    v_fmac_f32 v98, v15, v102
    v_and_b32 v103, 0xffff0000, v63
    v_fmac_f32 v99, v15, v103
    global_load_dwordx4 v[48:51], v1, s[4:5] offset:0 nt
    global_load_dwordx4 v[52:55], v1, s[4:5] offset:1024 nt
    global_load_dwordx4 v[56:59], v1, s[4:5] offset:2048 nt
    global_load_dwordx4 v[60:63], v1, s[4:5] offset:3072 nt
    v_add_f32_dpp v96, v96, v96 quad_perm:[1,0,3,2] row_mask:0xf bank_mask:0xf
    v_add_f32_dpp v97, v97, v97 quad_perm:[1,0,3,2] row_mask:0xf bank_mask:0xf
    v_add_f32_dpp v98, v98, v98 quad_perm:[1,0,3,2] row_mask:0xf bank_mask:0xf
    v_add_f32_dpp v99, v99, v99 quad_perm:[1,0,3,2] row_mask:0xf bank_mask:0xf
    v_add_f32_dpp v96, v96, v96 quad_perm:[2,3,0,1] row_mask:0xf bank_mask:0xf
    v_add_f32_dpp v97, v97, v97 quad_perm:[2,3,0,1] row_mask:0xf bank_mask:0xf
    v_add_f32_dpp v98, v98, v98 quad_perm:[2,3,0,1] row_mask:0xf bank_mask:0xf
    v_add_f32_dpp v99, v99, v99 quad_perm:[2,3,0,1] row_mask:0xf bank_mask:0xf
    v_add_f32_dpp v96, v96, v96 row_half_mirror row_mask:0xf bank_mask:0xf
    v_add_f32_dpp v97, v97, v97 row_half_mirror row_mask:0xf bank_mask:0xf
    v_add_f32_dpp v98, v98, v98 row_half_mirror row_mask:0xf bank_mask:0xf
    v_add_f32_dpp v99, v99, v99 row_half_mirror row_mask:0xf bank_mask:0xf
    v_add_f32_dpp v96, v96, v96 row_mirror row_mask:0xf bank_mask:0xf
    v_add_f32_dpp v97, v97, v97 row_mirror row_mask:0xf bank_mask:0xf
    v_add_f32_dpp v98, v98, v98 row_mirror row_mask:0xf bank_mask:0xf
    v_add_f32_dpp v99, v99, v99 row_mirror row_mask:0xf bank_mask:0xf
    v_max3_f32 v104, v96, v97, v24
    v_max3_f32 v104, v98, v99, v104
    v_sub_f32 v105, v24, v104
    v_exp_f32 v105, v105
    v_sub_f32 v96, v96, v104
    v_sub_f32 v97, v97, v104
    v_sub_f32 v98, v98, v104
    v_sub_f32 v99, v99, v104
    v_exp_f32 v96, v96
    v_exp_f32 v97, v97
    v_exp_f32 v98, v98
    v_exp_f32 v99, v99
    v_mov_b32 v24, v104
    v_mul_f32 v25, v25, v105
    v_mul_f32 v16, v16, v105
    v_mul_f32 v17, v17, v105
    v_mul_f32 v18, v18, v105
    v_mul_f32 v19, v19, v105
    v_mul_f32 v20, v20, v105
    v_mul_f32 v21, v21, v105
    v_mul_f32 v22, v22, v105
    v_mul_f32 v23, v23, v105
    v_add_f32 v25, v25, v96
    v_add_f32 v25, v25, v97
    v_add_f32 v25, v25, v98
    v_add_f32 v25, v25, v99
    s_waitcnt vmcnt(12)
    v_lshlrev_b32 v100, 16, v80
    v_fmac_f32 v16, v96, v100
    v_and_b32 v101, 0xffff0000, v80
    v_fmac_f32 v17, v96, v101
    v_lshlrev_b32 v102, 16, v81
    v_fmac_f32 v18, v96, v102
    v_and_b32 v103, 0xffff0000, v81
    v_fmac_f32 v19, v96, v103
    v_lshlrev_b32 v100, 16, v82
    v_fmac_f32 v20, v96, v100
    v_and_b32 v101, 0xffff0000, v82
    v_fmac_f32 v21, v96, v101
    v_lshlrev_b32 v102, 16, v83
    v_fmac_f32 v22, v96, v102
    v_and_b32 v103, 0xffff0000, v83
    v_fmac_f32 v23, v96, v103
    v_lshlrev_b32 v100, 16, v84
    v_fmac_f32 v16, v97, v100
    v_and_b32 v101, 0xffff0000, v84
    v_fmac_f32 v17, v97, v101
    v_lshlrev_b32 v102, 16, v85
    v_fmac_f32 v18, v97, v102
    v_and_b32 v103, 0xffff0000, v85
    v_fmac_f32 v19, v97, v103
    v_lshlrev_b32 v100, 16, v86
    v_fmac_f32 v20, v97, v100
    v_and_b32 v101, 0xffff0000, v86
    v_fmac_f32 v21, v97, v101
    v_lshlrev_b32 v102, 16, v87
    v_fmac_f32 v22, v97, v102
    v_and_b32 v103, 0xffff0000, v87
    v_fmac_f32 v23, v97, v103
    v_lshlrev_b32 v100, 16, v88
    v_fmac_f32 v16, v98, v100
    v_and_b32 v101, 0xffff0000, v88
    v_fmac_f32 v17, v98, v101
    v_lshlrev_b32 v102, 16, v89
    v_fmac_f32 v18, v98, v102
    v_and_b32 v103, 0xffff0000, v89
    v_fmac_f32 v19, v98, v103
    v_lshlrev_b32 v100, 16, v90
    v_fmac_f32 v20, v98, v100
    v_and_b32 v101, 0xffff0000, v90
    v_fmac_f32 v21, v98, v101
    v_lshlrev_b32 v102, 16, v91
    v_fmac_f32 v22, v98, v102
    v_and_b32 v103, 0xffff0000, v91
    v_fmac_f32 v23, v98, v103
    v_lshlrev_b32 v100, 16, v92
    v_fmac_f32 v16, v99, v100
    v_and_b32 v101, 0xffff0000, v92
    v_fmac_f32 v17, v99, v101
    v_lshlrev_b32 v102, 16, v93
    v_fmac_f32 v18, v99, v102
    v_and_b32 v103, 0xffff0000, v93
    v_fmac_f32 v19, v99, v103
    v_lshlrev_b32 v100, 16, v94
    v_fmac_f32 v20, v99, v100
    v_and_b32 v101, 0xffff0000, v94
    v_fmac_f32 v21, v99, v101
    v_lshlrev_b32 v102, 16, v95
    v_fmac_f32 v22, v99, v102
    v_and_b32 v103, 0xffff0000, v95
    v_fmac_f32 v23, v99, v103
    global_load_dwordx4 v[80:83], v1, s[6:7] offset:0 nt
    global_load_dwordx4 v[84:87], v1, s[6:7] offset:1024 nt
    global_load_dwordx4 v[88:91], v1, s[6:7] offset:2048 nt
    global_load_dwordx4 v[92:95], v1, s[6:7] offset:3072 nt
    v_add_u32 v1, 0x1000, v1
    v_and_b32 v1, 0x7fff, v1
    s_waitcnt vmcnt(12)
    v_lshlrev_b32 v100, 16, v32
    v_mul_f32 v96, v8, v100
    v_lshlrev_b32 v101, 16, v36
    v_mul_f32 v97, v8, v101
    v_lshlrev_b32 v102, 16, v40
    v_mul_f32 v98, v8, v102
    v_lshlrev_b32 v103, 16, v44
    v_mul_f32 v99, v8, v103
    v_and_b32 v100, 0xffff0000, v32
    v_fmac_f32 v96, v9, v100
    v_and_b32 v101, 0xffff0000, v36
    v_fmac_f32 v97, v9, v101
    v_and_b32 v102, 0xffff0000, v40
    v_fmac_f32 v98, v9, v102
    v_and_b32 v103, 0xffff0000, v44
    v_fmac_f32 v99, v9, v103
    v_lshlrev_b32 v100, 16, v33
    v_fmac_f32 v96, v10, v100
    v_lshlrev_b32 v101, 16, v37
    v_fmac_f32 v97, v10, v101
    v_lshlrev_b32 v102, 16, v41
    v_fmac_f32 v98, v10, v102
    v_lshlrev_b32 v103, 16, v45
    v_fmac_f32 v99, v10, v103
    v_and_b32 v100, 0xffff0000, v33
    v_fmac_f32 v96, v11, v100
    v_and_b32 v101, 0xffff0000, v37
    v_fmac_f32 v97, v11, v101
    v_and_b32 v102, 0xffff0000, v41
    v_fmac_f32 v98, v11, v102
    v_and_b32 v103, 0xffff0000, v45
    v_fmac_f32 v99, v11, v103
    v_lshlrev_b32 v100, 16, v34
    v_fmac_f32 v96, v12, v100
    v_lshlrev_b32 v101, 16, v38
    v_fmac_f32 v97, v12, v101
    v_lshlrev_b32 v102, 16, v42
    v_fmac_f32 v98, v12, v102
    v_lshlrev_b32 v103, 16, v46
    v_fmac_f32 v99, v12, v103
    v_and_b32 v100, 0xffff0000, v34
    v_fmac_f32 v96, v13, v100
    v_and_b32 v101, 0xffff0000, v38
    v_fmac_f32 v97, v13, v101
    v_and_b32 v102, 0xffff0000, v42
    v_fmac_f32 v98, v13, v102
    v_and_b32 v103, 0xffff0000, v46
    v_fmac_f32 v99, v13, v103
    v_lshlrev_b32 v100, 16, v35
    v_fmac_f32 v96, v14, v100
    v_lshlrev_b32 v101, 16, v39
    v_fmac_f32 v97, v14, v101
    v_lshlrev_b32 v102, 16, v43
    v_fmac_f32 v98, v14, v102
    v_lshlrev_b32 v103, 16, v47
    v_fmac_f32 v99, v14, v103
    v_and_b32 v100, 0xffff0000, v35
    v_fmac_f32 v96, v15, v100
    v_and_b32 v101, 0xffff0000, v39
    v_fmac_f32 v97, v15, v101
    v_and_b32 v102, 0xffff0000, v43
    v_fmac_f32 v98, v15, v102
    v_and_b32 v103, 0xffff0000, v47
    v_fmac_f32 v99, v15, v103
    global_load_dwordx4 v[32:35], v1, s[4:5] offset:0 nt
    global_load_dwordx4 v[36:39], v1, s[4:5] offset:1024 nt
    global_load_dwordx4 v[40:43], v1, s[4:5] offset:2048 nt
    global_load_dwordx4 v[44:47], v1, s[4:5] offset:3072 nt
    v_add_f32_dpp v96, v96, v96 quad_perm:[1,0,3,2] row_mask:0xf bank_mask:0xf
    v_add_f32_dpp v97, v97, v97 quad_perm:[1,0,3,2] row_mask:0xf bank_mask:0xf
    v_add_f32_dpp v98, v98, v98 quad_perm:[1,0,3,2] row_mask:0xf bank_mask:0xf
    v_add_f32_dpp v99, v99, v99 quad_perm:[1,0,3,2] row_mask:0xf bank_mask:0xf
    v_add_f32_dpp v96, v96, v96 quad_perm:[2,3,0,1] row_mask:0xf bank_mask:0xf
    v_add_f32_dpp v97, v97, v97 quad_perm:[2,3,0,1] row_mask:0xf bank_mask:0xf
    v_add_f32_dpp v98, v98, v98 quad_perm:[2,3,0,1] row_mask:0xf bank_mask:0xf
    v_add_f32_dpp v99, v99, v99 quad_perm:[2,3,0,1] row_mask:0xf bank_mask:0xf
    v_add_f32_dpp v96, v96, v96 row_half_mirror row_mask:0xf bank_mask:0xf
    v_add_f32_dpp v97, v97, v97 row_half_mirror row_mask:0xf bank_mask:0xf
    v_add_f32_dpp v98, v98, v98 row_half_mirror row_mask:0xf bank_mask:0xf
    v_add_f32_dpp v99, v99, v99 row_half_mirror row_mask:0xf bank_mask:0xf
    v_add_f32_dpp v96, v96, v96 row_mirror row_mask:0xf bank_mask:0xf
    v_add_f32_dpp v97, v97, v97 row_mirror row_mask:0xf bank_mask:0xf
    v_add_f32_dpp v98, v98, v98 row_mirror row_mask:0xf bank_mask:0xf
    v_add_f32_dpp v99, v99, v99 row_mirror row_mask:0xf bank_mask:0xf
    v_max3_f32 v104, v96, v97, v24
    v_max3_f32 v104, v98, v99, v104
    v_sub_f32 v105, v24, v104
    v_exp_f32 v105, v105
    v_sub_f32 v96, v96, v104
    v_sub_f32 v97, v97, v104
    v_sub_f32 v98, v98, v104
    v_sub_f32 v99, v99, v104
    v_exp_f32 v96, v96
    v_exp_f32 v97, v97
    v_exp_f32 v98, v98
    v_exp_f32 v99, v99
    v_mov_b32 v24, v104
    v_mul_f32 v25, v25, v105
    v_mul_f32 v16, v16, v105
    v_mul_f32 v17, v17, v105
    v_mul_f32 v18, v18, v105
    v_mul_f32 v19, v19, v105
    v_mul_f32 v20, v20, v105
    v_mul_f32 v21, v21, v105
    v_mul_f32 v22, v22, v105
    v_mul_f32 v23, v23, v105
    v_add_f32 v25, v25, v96
    v_add_f32 v25, v25, v97
    v_add_f32 v25, v25, v98
    v_add_f32 v25, v25, v99
    s_waitcnt vmcnt(12)
    v_lshlrev_b32 v100, 16, v64
    v_fmac_f32 v16, v96, v100
    v_and_b32 v101, 0xffff0000, v64
    v_fmac_f32 v17, v96, v101
    v_lshlrev_b32 v102, 16, v65
    v_fmac_f32 v18, v96, v102
    v_and_b32 v103, 0xffff0000, v65
    v_fmac_f32 v19, v96, v103
    v_lshlrev_b32 v100, 16, v66
    v_fmac_f32 v20, v96, v100
    v_and_b32 v101, 0xffff0000, v66
    v_fmac_f32 v21, v96, v101
    v_lshlrev_b32 v102, 16, v67
    v_fmac_f32 v22, v96, v102
    v_and_b32 v103, 0xffff0000, v67
    v_fmac_f32 v23, v96, v103
    v_lshlrev_b32 v100, 16, v68
    v_fmac_f32 v16, v97, v100
    v_and_b32 v101, 0xffff0000, v68
    v_fmac_f32 v17, v97, v101
    v_lshlrev_b32 v102, 16, v69
    v_fmac_f32 v18, v97, v102
    v_and_b32 v103, 0xffff0000, v69
    v_fmac_f32 v19, v97, v103
    v_lshlrev_b32 v100, 16, v70
    v_fmac_f32 v20, v97, v100
    v_and_b32 v101, 0xffff0000, v70
    v_fmac_f32 v21, v97, v101
    v_lshlrev_b32 v102, 16, v71
    v_fmac_f32 v22, v97, v102
    v_and_b32 v103, 0xffff0000, v71
    v_fmac_f32 v23, v97, v103
    v_lshlrev_b32 v100, 16, v72
    v_fmac_f32 v16, v98, v100
    v_and_b32 v101, 0xffff0000, v72
    v_fmac_f32 v17, v98, v101
    v_lshlrev_b32 v102, 16, v73
    v_fmac_f32 v18, v98, v102
    v_and_b32 v103, 0xffff0000, v73
    v_fmac_f32 v19, v98, v103
    v_lshlrev_b32 v100, 16, v74
    v_fmac_f32 v20, v98, v100
    v_and_b32 v101, 0xffff0000, v74
    v_fmac_f32 v21, v98, v101
    v_lshlrev_b32 v102, 16, v75
    v_fmac_f32 v22, v98, v102
    v_and_b32 v103, 0xffff0000, v75
    v_fmac_f32 v23, v98, v103
    v_lshlrev_b32 v100, 16, v76
    v_fmac_f32 v16, v99, v100
    v_and_b32 v101, 0xffff0000, v76
    v_fmac_f32 v17, v99, v101
    v_lshlrev_b32 v102, 16, v77
    v_fmac_f32 v18, v99, v102
    v_and_b32 v103, 0xffff0000, v77
    v_fmac_f32 v19, v99, v103
    v_lshlrev_b32 v100, 16, v78
    v_fmac_f32 v20, v99, v100
    v_and_b32 v101, 0xffff0000, v78
    v_fmac_f32 v21, v99, v101
    v_lshlrev_b32 v102, 16, v79
    v_fmac_f32 v22, v99, v102
    v_and_b32 v103, 0xffff0000, v79
    v_fmac_f32 v23, v99, v103
    global_load_dwordx4 v[64:67], v1, s[6:7] offset:0 nt
    global_load_dwordx4 v[68:71], v1, s[6:7] offset:1024 nt
    global_load_dwordx4 v[72:75], v1, s[6:7] offset:2048 nt
    global_load_dwordx4 v[76:79], v1, s[6:7] offset:3072 nt
    v_add_u32 v1, 0x1000, v1
    v_and_b32 v1, 0x7fff, v1
    s_waitcnt vmcnt(12)
    v_lshlrev_b32 v100, 16, v48
    v_mul_f32 v96, v8, v100
    v_lshlrev_b32 v101, 16, v52
    v_mul_f32 v97, v8, v101
    v_lshlrev_b32 v102, 16, v56
    v_mul_f32 v98, v8, v102
    v_lshlrev_b32 v103, 16, v60
    v_mul_f32 v99, v8, v103
    v_and_b32 v100, 0xffff0000, v48
    v_fmac_f32 v96, v9, v100
    v_and_b32 v101, 0xffff0000, v52
    v_fmac_f32 v97, v9, v101
    v_and_b32 v102, 0xffff0000, v56
    v_fmac_f32 v98, v9, v102
    v_and_b32 v103, 0xffff0000, v60
    v_fmac_f32 v99, v9, v103
    v_lshlrev_b32 v100, 16, v49
    v_fmac_f32 v96, v10, v100
    v_lshlrev_b32 v101, 16, v53
    v_fmac_f32 v97, v10, v101
    v_lshlrev_b32 v102, 16, v57
    v_fmac_f32 v98, v10, v102
    v_lshlrev_b32 v103, 16, v61
    v_fmac_f32 v99, v10, v103
    v_and_b32 v100, 0xffff0000, v49
    v_fmac_f32 v96, v11, v100
    v_and_b32 v101, 0xffff0000, v53
    v_fmac_f32 v97, v11, v101
    v_and_b32 v102, 0xffff0000, v57
    v_fmac_f32 v98, v11, v102
    v_and_b32 v103, 0xffff0000, v61
    v_fmac_f32 v99, v11, v103
    v_lshlrev_b32 v100, 16, v50
    v_fmac_f32 v96, v12, v100
    v_lshlrev_b32 v101, 16, v54
    v_fmac_f32 v97, v12, v101
    v_lshlrev_b32 v102, 16, v58
    v_fmac_f32 v98, v12, v102
    v_lshlrev_b32 v103, 16, v62
    v_fmac_f32 v99, v12, v103
    v_and_b32 v100, 0xffff0000, v50
    v_fmac_f32 v96, v13, v100
    v_and_b32 v101, 0xffff0000, v54
    v_fmac_f32 v97, v13, v101
    v_and_b32 v102, 0xffff0000, v58
    v_fmac_f32 v98, v13, v102
    v_and_b32 v103, 0xffff0000, v62
    v_fmac_f32 v99, v13, v103
    v_lshlrev_b32 v100, 16, v51
    v_fmac_f32 v96, v14, v100
    v_lshlrev_b32 v101, 16, v55
    v_fmac_f32 v97, v14, v101
    v_lshlrev_b32 v102, 16, v59
    v_fmac_f32 v98, v14, v102
    v_lshlrev_b32 v103, 16, v63
    v_fmac_f32 v99, v14, v103
    v_and_b32 v100, 0xffff0000, v51
    v_fmac_f32 v96, v15, v100
    v_and_b32 v101, 0xffff0000, v55
    v_fmac_f32 v97, v15, v101
    v_and_b32 v102, 0xffff0000, v59
    v_fmac_f32 v98, v15, v102
    v_and_b32 v103, 0xffff0000, v63
    v_fmac_f32 v99, v15, v103
    global_load_dwordx4 v[48:51], v1, s[4:5] offset:0 nt
    global_load_dwordx4 v[52:55], v1, s[4:5] offset:1024 nt
    global_load_dwordx4 v[56:59], v1, s[4:5] offset:2048 nt
    global_load_dwordx4 v[60:63], v1, s[4:5] offset:3072 nt
    v_add_f32_dpp v96, v96, v96 quad_perm:[1,0,3,2] row_mask:0xf bank_mask:0xf
    v_add_f32_dpp v97, v97, v97 quad_perm:[1,0,3,2] row_mask:0xf bank_mask:0xf
    v_add_f32_dpp v98, v98, v98 quad_perm:[1,0,3,2] row_mask:0xf bank_mask:0xf
    v_add_f32_dpp v99, v99, v99 quad_perm:[1,0,3,2] row_mask:0xf bank_mask:0xf
    v_add_f32_dpp v96, v96, v96 quad_perm:[2,3,0,1] row_mask:0xf bank_mask:0xf
    v_add_f32_dpp v97, v97, v97 quad_perm:[2,3,0,1] row_mask:0xf bank_mask:0xf
    v_add_f32_dpp v98, v98, v98 quad_perm:[2,3,0,1] row_mask:0xf bank_mask:0xf
    v_add_f32_dpp v99, v99, v99 quad_perm:[2,3,0,1] row_mask:0xf bank_mask:0xf
    v_add_f32_dpp v96, v96, v96 row_half_mirror row_mask:0xf bank_mask:0xf
    v_add_f32_dpp v97, v97, v97 row_half_mirror row_mask:0xf bank_mask:0xf
    v_add_f32_dpp v98, v98, v98 row_half_mirror row_mask:0xf bank_mask:0xf
    v_add_f32_dpp v99, v99, v99 row_half_mirror row_mask:0xf bank_mask:0xf
    v_add_f32_dpp v96, v96, v96 row_mirror row_mask:0xf bank_mask:0xf
    v_add_f32_dpp v97, v97, v97 row_mirror row_mask:0xf bank_mask:0xf
    v_add_f32_dpp v98, v98, v98 row_mirror row_mask:0xf bank_mask:0xf
    v_add_f32_dpp v99, v99, v99 row_mirror row_mask:0xf bank_mask:0xf
    v_max3_f32 v104, v96, v97, v24
    v_max3_f32 v104, v98, v99, v104
    v_sub_f32 v105, v24, v104
    v_exp_f32 v105, v105
    v_sub_f32 v96, v96, v104
    v_sub_f32 v97, v97, v104
    v_sub_f32 v98, v98, v104
    v_sub_f32 v99, v99, v104
    v_exp_f32 v96, v96
    v_exp_f32 v97, v97
    v_exp_f32 v98, v98
    v_exp_f32 v99, v99
    v_mov_b32 v24, v104
    v_mul_f32 v25, v25, v105
    v_mul_f32 v16, v16, v105
    v_mul_f32 v17, v17, v105
    v_mul_f32 v18, v18, v105
    v_mul_f32 v19, v19, v105
    v_mul_f32 v20, v20, v105
    v_mul_f32 v21, v21, v105
    v_mul_f32 v22, v22, v105
    v_mul_f32 v23, v23, v105
    v_add_f32 v25, v25, v96
    v_add_f32 v25, v25, v97
    v_add_f32 v25, v25, v98
    v_add_f32 v25, v25, v99
    s_waitcnt vmcnt(12)
    v_lshlrev_b32 v100, 16, v80
    v_fmac_f32 v16, v96, v100
    v_and_b32 v101, 0xffff0000, v80
    v_fmac_f32 v17, v96, v101
    v_lshlrev_b32 v102, 16, v81
    v_fmac_f32 v18, v96, v102
    v_and_b32 v103, 0xffff0000, v81
    v_fmac_f32 v19, v96, v103
    v_lshlrev_b32 v100, 16, v82
    v_fmac_f32 v20, v96, v100
    v_and_b32 v101, 0xffff0000, v82
    v_fmac_f32 v21, v96, v101
    v_lshlrev_b32 v102, 16, v83
    v_fmac_f32 v22, v96, v102
    v_and_b32 v103, 0xffff0000, v83
    v_fmac_f32 v23, v96, v103
    v_lshlrev_b32 v100, 16, v84
    v_fmac_f32 v16, v97, v100
    v_and_b32 v101, 0xffff0000, v84
    v_fmac_f32 v17, v97, v101
    v_lshlrev_b32 v102, 16, v85
    v_fmac_f32 v18, v97, v102
    v_and_b32 v103, 0xffff0000, v85
    v_fmac_f32 v19, v97, v103
    v_lshlrev_b32 v100, 16, v86
    v_fmac_f32 v20, v97, v100
    v_and_b32 v101, 0xffff0000, v86
    v_fmac_f32 v21, v97, v101
    v_lshlrev_b32 v102, 16, v87
    v_fmac_f32 v22, v97, v102
    v_and_b32 v103, 0xffff0000, v87
    v_fmac_f32 v23, v97, v103
    v_lshlrev_b32 v100, 16, v88
    v_fmac_f32 v16, v98, v100
    v_and_b32 v101, 0xffff0000, v88
    v_fmac_f32 v17, v98, v101
    v_lshlrev_b32 v102, 16, v89
    v_fmac_f32 v18, v98, v102
    v_and_b32 v103, 0xffff0000, v89
    v_fmac_f32 v19, v98, v103
    v_lshlrev_b32 v100, 16, v90
    v_fmac_f32 v20, v98, v100
    v_and_b32 v101, 0xffff0000, v90
    v_fmac_f32 v21, v98, v101
    v_lshlrev_b32 v102, 16, v91
    v_fmac_f32 v22, v98, v102
    v_and_b32 v103, 0xffff0000, v91
    v_fmac_f32 v23, v98, v103
    v_lshlrev_b32 v100, 16, v92
    v_fmac_f32 v16, v99, v100
    v_and_b32 v101, 0xffff0000, v92
    v_fmac_f32 v17, v99, v101
    v_lshlrev_b32 v102, 16, v93
    v_fmac_f32 v18, v99, v102
    v_and_b32 v103, 0xffff0000, v93
    v_fmac_f32 v19, v99, v103
    v_lshlrev_b32 v100, 16, v94
    v_fmac_f32 v20, v99, v100
    v_and_b32 v101, 0xffff0000, v94
    v_fmac_f32 v21, v99, v101
    v_lshlrev_b32 v102, 16, v95
    v_fmac_f32 v22, v99, v102
    v_and_b32 v103, 0xffff0000, v95
    v_fmac_f32 v23, v99, v103
    global_load_dwordx4 v[80:83], v1, s[6:7] offset:0 nt
    global_load_dwordx4 v[84:87], v1, s[6:7] offset:1024 nt
    global_load_dwordx4 v[88:91], v1, s[6:7] offset:2048 nt
    global_load_dwordx4 v[92:95], v1, s[6:7] offset:3072 nt
    v_add_u32 v1, 0x1000, v1
    v_and_b32 v1, 0x7fff, v1
    s_waitcnt vmcnt(12)
    v_lshlrev_b32 v100, 16, v32
    v_mul_f32 v96, v8, v100
    v_lshlrev_b32 v101, 16, v36
    v_mul_f32 v97, v8, v101
    v_lshlrev_b32 v102, 16, v40
    v_mul_f32 v98, v8, v102
    v_lshlrev_b32 v103, 16, v44
    v_mul_f32 v99, v8, v103
    v_and_b32 v100, 0xffff0000, v32
    v_fmac_f32 v96, v9, v100
    v_and_b32 v101, 0xffff0000, v36
    v_fmac_f32 v97, v9, v101
    v_and_b32 v102, 0xffff0000, v40
    v_fmac_f32 v98, v9, v102
    v_and_b32 v103, 0xffff0000, v44
    v_fmac_f32 v99, v9, v103
    v_lshlrev_b32 v100, 16, v33
    v_fmac_f32 v96, v10, v100
    v_lshlrev_b32 v101, 16, v37
    v_fmac_f32 v97, v10, v101
    v_lshlrev_b32 v102, 16, v41
    v_fmac_f32 v98, v10, v102
    v_lshlrev_b32 v103, 16, v45
    v_fmac_f32 v99, v10, v103
    v_and_b32 v100, 0xffff0000, v33
    v_fmac_f32 v96, v11, v100
    v_and_b32 v101, 0xffff0000, v37
    v_fmac_f32 v97, v11, v101
    v_and_b32 v102, 0xffff0000, v41
    v_fmac_f32 v98, v11, v102
    v_and_b32 v103, 0xffff0000, v45
    v_fmac_f32 v99, v11, v103
    v_lshlrev_b32 v100, 16, v34
    v_fmac_f32 v96, v12, v100
    v_lshlrev_b32 v101, 16, v38
    v_fmac_f32 v97, v12, v101
    v_lshlrev_b32 v102, 16, v42
    v_fmac_f32 v98, v12, v102
    v_lshlrev_b32 v103, 16, v46
    v_fmac_f32 v99, v12, v103
    v_and_b32 v100, 0xffff0000, v34
    v_fmac_f32 v96, v13, v100
    v_and_b32 v101, 0xffff0000, v38
    v_fmac_f32 v97, v13, v101
    v_and_b32 v102, 0xffff0000, v42
    v_fmac_f32 v98, v13, v102
    v_and_b32 v103, 0xffff0000, v46
    v_fmac_f32 v99, v13, v103
    v_lshlrev_b32 v100, 16, v35
    v_fmac_f32 v96, v14, v100
    v_lshlrev_b32 v101, 16, v39
    v_fmac_f32 v97, v14, v101
    v_lshlrev_b32 v102, 16, v43
    v_fmac_f32 v98, v14, v102
    v_lshlrev_b32 v103, 16, v47
    v_fmac_f32 v99, v14, v103
    v_and_b32 v100, 0xffff0000, v35
    v_fmac_f32 v96, v15, v100
    v_and_b32 v101, 0xffff0000, v39
    v_fmac_f32 v97, v15, v101
    v_and_b32 v102, 0xffff0000, v43
    v_fmac_f32 v98, v15, v102
    v_and_b32 v103, 0xffff0000, v47
    v_fmac_f32 v99, v15, v103
    global_load_dwordx4 v[32:35], v1, s[4:5] offset:0 nt
    global_load_dwordx4 v[36:39], v1, s[4:5] offset:1024 nt
    global_load_dwordx4 v[40:43], v1, s[4:5] offset:2048 nt
    global_load_dwordx4 v[44:47], v1, s[4:5] offset:3072 nt
    v_add_f32_dpp v96, v96, v96 quad_perm:[1,0,3,2] row_mask:0xf bank_mask:0xf
    v_add_f32_dpp v97, v97, v97 quad_perm:[1,0,3,2] row_mask:0xf bank_mask:0xf
    v_add_f32_dpp v98, v98, v98 quad_perm:[1,0,3,2] row_mask:0xf bank_mask:0xf
    v_add_f32_dpp v99, v99, v99 quad_perm:[1,0,3,2] row_mask:0xf bank_mask:0xf
    v_add_f32_dpp v96, v96, v96 quad_perm:[2,3,0,1] row_mask:0xf bank_mask:0xf
    v_add_f32_dpp v97, v97, v97 quad_perm:[2,3,0,1] row_mask:0xf bank_mask:0xf
    v_add_f32_dpp v98, v98, v98 quad_perm:[2,3,0,1] row_mask:0xf bank_mask:0xf
    v_add_f32_dpp v99, v99, v99 quad_perm:[2,3,0,1] row_mask:0xf bank_mask:0xf
    v_add_f32_dpp v96, v96, v96 row_half_mirror row_mask:0xf bank_mask:0xf
    v_add_f32_dpp v97, v97, v97 row_half_mirror row_mask:0xf bank_mask:0xf
    v_add_f32_dpp v98, v98, v98 row_half_mirror row_mask:0xf bank_mask:0xf
    v_add_f32_dpp v99, v99, v99 row_half_mirror row_mask:0xf bank_mask:0xf
    v_add_f32_dpp v96, v96, v96 row_mirror row_mask:0xf bank_mask:0xf
    v_add_f32_dpp v97, v97, v97 row_mirror row_mask:0xf bank_mask:0xf
    v_add_f32_dpp v98, v98, v98 row_mirror row_mask:0xf bank_mask:0xf
    v_add_f32_dpp v99, v99, v99 row_mirror row_mask:0xf bank_mask:0xf
    v_max3_f32 v104, v96, v97, v24
    v_max3_f32 v104, v98, v99, v104
    v_sub_f32 v105, v24, v104
    v_exp_f32 v105, v105
    v_sub_f32 v96, v96, v104
    v_sub_f32 v97, v97, v104
    v_sub_f32 v98, v98, v104
    v_sub_f32 v99, v99, v104
    v_exp_f32 v96, v96
    v_exp_f32 v97, v97
    v_exp_f32 v98, v98
    v_exp_f32 v99, v99
    v_mov_b32 v24, v104
    v_mul_f32 v25, v25, v105
    v_mul_f32 v16, v16, v105
    v_mul_f32 v17, v17, v105
    v_mul_f32 v18, v18, v105
    v_mul_f32 v19, v19, v105
    v_mul_f32 v20, v20, v105
    v_mul_f32 v21, v21, v105
    v_mul_f32 v22, v22, v105
    v_mul_f32 v23, v23, v105
    v_add_f32 v25, v25, v96
    v_add_f32 v25, v25, v97
    v_add_f32 v25, v25, v98
    v_add_f32 v25, v25, v99
    s_waitcnt vmcnt(12)
    v_lshlrev_b32 v100, 16, v64
    v_fmac_f32 v16, v96, v100
    v_and_b32 v101, 0xffff0000, v64
    v_fmac_f32 v17, v96, v101
    v_lshlrev_b32 v102, 16, v65
    v_fmac_f32 v18, v96, v102
    v_and_b32 v103, 0xffff0000, v65
    v_fmac_f32 v19, v96, v103
    v_lshlrev_b32 v100, 16, v66
    v_fmac_f32 v20, v96, v100
    v_and_b32 v101, 0xffff0000, v66
    v_fmac_f32 v21, v96, v101
    v_lshlrev_b32 v102, 16, v67
    v_fmac_f32 v22, v96, v102
    v_and_b32 v103, 0xffff0000, v67
    v_fmac_f32 v23, v96, v103
    v_lshlrev_b32 v100, 16, v68
    v_fmac_f32 v16, v97, v100
    v_and_b32 v101, 0xffff0000, v68
    v_fmac_f32 v17, v97, v101
    v_lshlrev_b32 v102, 16, v69
    v_fmac_f32 v18, v97, v102
    v_and_b32 v103, 0xffff0000, v69
    v_fmac_f32 v19, v97, v103
    v_lshlrev_b32 v100, 16, v70
    v_fmac_f32 v20, v97, v100
    v_and_b32 v101, 0xffff0000, v70
    v_fmac_f32 v21, v97, v101
    v_lshlrev_b32 v102, 16, v71
    v_fmac_f32 v22, v97, v102
    v_and_b32 v103, 0xffff0000, v71
    v_fmac_f32 v23, v97, v103
    v_lshlrev_b32 v100, 16, v72
    v_fmac_f32 v16, v98, v100
    v_and_b32 v101, 0xffff0000, v72
    v_fmac_f32 v17, v98, v101
    v_lshlrev_b32 v102, 16, v73
    v_fmac_f32 v18, v98, v102
    v_and_b32 v103, 0xffff0000, v73
    v_fmac_f32 v19, v98, v103
    v_lshlrev_b32 v100, 16, v74
    v_fmac_f32 v20, v98, v100
    v_and_b32 v101, 0xffff0000, v74
    v_fmac_f32 v21, v98, v101
    v_lshlrev_b32 v102, 16, v75
    v_fmac_f32 v22, v98, v102
    v_and_b32 v103, 0xffff0000, v75
    v_fmac_f32 v23, v98, v103
    v_lshlrev_b32 v100, 16, v76
    v_fmac_f32 v16, v99, v100
    v_and_b32 v101, 0xffff0000, v76
    v_fmac_f32 v17, v99, v101
    v_lshlrev_b32 v102, 16, v77
    v_fmac_f32 v18, v99, v102
    v_and_b32 v103, 0xffff0000, v77
    v_fmac_f32 v19, v99, v103
    v_lshlrev_b32 v100, 16, v78
    v_fmac_f32 v20, v99, v100
    v_and_b32 v101, 0xffff0000, v78
    v_fmac_f32 v21, v99, v101
    v_lshlrev_b32 v102, 16, v79
    v_fmac_f32 v22, v99, v102
    v_and_b32 v103, 0xffff0000, v79
    v_fmac_f32 v23, v99, v103
    global_load_dwordx4 v[64:67], v1, s[6:7] offset:0 nt
    global_load_dwordx4 v[68:71], v1, s[6:7] offset:1024 nt
    global_load_dwordx4 v[72:75], v1, s[6:7] offset:2048 nt
    global_load_dwordx4 v[76:79], v1, s[6:7] offset:3072 nt
    v_add_u32 v1, 0x1000, v1
    v_and_b32 v1, 0x7fff, v1
    s_waitcnt vmcnt(12)
    v_lshlrev_b32 v100, 16, v48
    v_mul_f32 v96, v8, v100
    v_lshlrev_b32 v101, 16, v52
    v_mul_f32 v97, v8, v101
    v_lshlrev_b32 v102, 16, v56
    v_mul_f32 v98, v8, v102
    v_lshlrev_b32 v103, 16, v60
    v_mul_f32 v99, v8, v103
    v_and_b32 v100, 0xffff0000, v48
    v_fmac_f32 v96, v9, v100
    v_and_b32 v101, 0xffff0000, v52
    v_fmac_f32 v97, v9, v101
    v_and_b32 v102, 0xffff0000, v56
    v_fmac_f32 v98, v9, v102
    v_and_b32 v103, 0xffff0000, v60
    v_fmac_f32 v99, v9, v103
    v_lshlrev_b32 v100, 16, v49
    v_fmac_f32 v96, v10, v100
    v_lshlrev_b32 v101, 16, v53
    v_fmac_f32 v97, v10, v101
    v_lshlrev_b32 v102, 16, v57
    v_fmac_f32 v98, v10, v102
    v_lshlrev_b32 v103, 16, v61
    v_fmac_f32 v99, v10, v103
    v_and_b32 v100, 0xffff0000, v49
    v_fmac_f32 v96, v11, v100
    v_and_b32 v101, 0xffff0000, v53
    v_fmac_f32 v97, v11, v101
    v_and_b32 v102, 0xffff0000, v57
    v_fmac_f32 v98, v11, v102
    v_and_b32 v103, 0xffff0000, v61
    v_fmac_f32 v99, v11, v103
    v_lshlrev_b32 v100, 16, v50
    v_fmac_f32 v96, v12, v100
    v_lshlrev_b32 v101, 16, v54
    v_fmac_f32 v97, v12, v101
    v_lshlrev_b32 v102, 16, v58
    v_fmac_f32 v98, v12, v102
    v_lshlrev_b32 v103, 16, v62
    v_fmac_f32 v99, v12, v103
    v_and_b32 v100, 0xffff0000, v50
    v_fmac_f32 v96, v13, v100
    v_and_b32 v101, 0xffff0000, v54
    v_fmac_f32 v97, v13, v101
    v_and_b32 v102, 0xffff0000, v58
    v_fmac_f32 v98, v13, v102
    v_and_b32 v103, 0xffff0000, v62
    v_fmac_f32 v99, v13, v103
    v_lshlrev_b32 v100, 16, v51
    v_fmac_f32 v96, v14, v100
    v_lshlrev_b32 v101, 16, v55
    v_fmac_f32 v97, v14, v101
    v_lshlrev_b32 v102, 16, v59
    v_fmac_f32 v98, v14, v102
    v_lshlrev_b32 v103, 16, v63
    v_fmac_f32 v99, v14, v103
    v_and_b32 v100, 0xffff0000, v51
    v_fmac_f32 v96, v15, v100
    v_and_b32 v101, 0xffff0000, v55
    v_fmac_f32 v97, v15, v101
    v_and_b32 v102, 0xffff0000, v59
    v_fmac_f32 v98, v15, v102
    v_and_b32 v103, 0xffff0000, v63
    v_fmac_f32 v99, v15, v103
    global_load_dwordx4 v[48:51], v1, s[4:5] offset:0 nt
    global_load_dwordx4 v[52:55], v1, s[4:5] offset:1024 nt
    global_load_dwordx4 v[56:59], v1, s[4:5] offset:2048 nt
    global_load_dwordx4 v[60:63], v1, s[4:5] offset:3072 nt
    v_add_f32_dpp v96, v96, v96 quad_perm:[1,0,3,2] row_mask:0xf bank_mask:0xf
    v_add_f32_dpp v97, v97, v97 quad_perm:[1,0,3,2] row_mask:0xf bank_mask:0xf
    v_add_f32_dpp v98, v98, v98 quad_perm:[1,0,3,2] row_mask:0xf bank_mask:0xf
    v_add_f32_dpp v99, v99, v99 quad_perm:[1,0,3,2] row_mask:0xf bank_mask:0xf
    v_add_f32_dpp v96, v96, v96 quad_perm:[2,3,0,1] row_mask:0xf bank_mask:0xf
    v_add_f32_dpp v97, v97, v97 quad_perm:[2,3,0,1] row_mask:0xf bank_mask:0xf
    v_add_f32_dpp v98, v98, v98 quad_perm:[2,3,0,1] row_mask:0xf bank_mask:0xf
    v_add_f32_dpp v99, v99, v99 quad_perm:[2,3,0,1] row_mask:0xf bank_mask:0xf
    v_add_f32_dpp v96, v96, v96 row_half_mirror row_mask:0xf bank_mask:0xf
    v_add_f32_dpp v97, v97, v97 row_half_mirror row_mask:0xf bank_mask:0xf
    v_add_f32_dpp v98, v98, v98 row_half_mirror row_mask:0xf bank_mask:0xf
    v_add_f32_dpp v99, v99, v99 row_half_mirror row_mask:0xf bank_mask:0xf
    v_add_f32_dpp v96, v96, v96 row_mirror row_mask:0xf bank_mask:0xf
    v_add_f32_dpp v97, v97, v97 row_mirror row_mask:0xf bank_mask:0xf
    v_add_f32_dpp v98, v98, v98 row_mirror row_mask:0xf bank_mask:0xf
    v_add_f32_dpp v99, v99, v99 row_mirror row_mask:0xf bank_mask:0xf
    v_max3_f32 v104, v96, v97, v24
    v_max3_f32 v104, v98, v99, v104
    v_sub_f32 v105, v24, v104
    v_exp_f32 v105, v105
    v_sub_f32 v96, v96, v104
    v_sub_f32 v97, v97, v104
    v_sub_f32 v98, v98, v104
    v_sub_f32 v99, v99, v104
    v_exp_f32 v96, v96
    v_exp_f32 v97, v97
    v_exp_f32 v98, v98
    v_exp_f32 v99, v99
    v_mov_b32 v24, v104
    v_mul_f32 v25, v25, v105
    v_mul_f32 v16, v16, v105
    v_mul_f32 v17, v17, v105
    v_mul_f32 v18, v18, v105
    v_mul_f32 v19, v19, v105
    v_mul_f32 v20, v20, v105
    v_mul_f32 v21, v21, v105
    v_mul_f32 v22, v22, v105
    v_mul_f32 v23, v23, v105
    v_add_f32 v25, v25, v96
    v_add_f32 v25, v25, v97
    v_add_f32 v25, v25, v98
    v_add_f32 v25, v25, v99
    s_waitcnt vmcnt(12)
    v_lshlrev_b32 v100, 16, v80
    v_fmac_f32 v16, v96, v100
    v_and_b32 v101, 0xffff0000, v80
    v_fmac_f32 v17, v96, v101
    v_lshlrev_b32 v102, 16, v81
    v_fmac_f32 v18, v96, v102
    v_and_b32 v103, 0xffff0000, v81
    v_fmac_f32 v19, v96, v103
    v_lshlrev_b32 v100, 16, v82
    v_fmac_f32 v20, v96, v100
    v_and_b32 v101, 0xffff0000, v82
    v_fmac_f32 v21, v96, v101
    v_lshlrev_b32 v102, 16, v83
    v_fmac_f32 v22, v96, v102
    v_and_b32 v103, 0xffff0000, v83
    v_fmac_f32 v23, v96, v103
    v_lshlrev_b32 v100, 16, v84
    v_fmac_f32 v16, v97, v100
    v_and_b32 v101, 0xffff0000, v84
    v_fmac_f32 v17, v97, v101
    v_lshlrev_b32 v102, 16, v85
    v_fmac_f32 v18, v97, v102
    v_and_b32 v103, 0xffff0000, v85
    v_fmac_f32 v19, v97, v103
    v_lshlrev_b32 v100, 16, v86
    v_fmac_f32 v20, v97, v100
    v_and_b32 v101, 0xffff0000, v86
    v_fmac_f32 v21, v97, v101
    v_lshlrev_b32 v102, 16, v87
    v_fmac_f32 v22, v97, v102
    v_and_b32 v103, 0xffff0000, v87
    v_fmac_f32 v23, v97, v103
    v_lshlrev_b32 v100, 16, v88
    v_fmac_f32 v16, v98, v100
    v_and_b32 v101, 0xffff0000, v88
    v_fmac_f32 v17, v98, v101
    v_lshlrev_b32 v102, 16, v89
    v_fmac_f32 v18, v98, v102
    v_and_b32 v103, 0xffff0000, v89
    v_fmac_f32 v19, v98, v103
    v_lshlrev_b32 v100, 16, v90
    v_fmac_f32 v20, v98, v100
    v_and_b32 v101, 0xffff0000, v90
    v_fmac_f32 v21, v98, v101
    v_lshlrev_b32 v102, 16, v91
    v_fmac_f32 v22, v98, v102
    v_and_b32 v103, 0xffff0000, v91
    v_fmac_f32 v23, v98, v103
    v_lshlrev_b32 v100, 16, v92
    v_fmac_f32 v16, v99, v100
    v_and_b32 v101, 0xffff0000, v92
    v_fmac_f32 v17, v99, v101
    v_lshlrev_b32 v102, 16, v93
    v_fmac_f32 v18, v99, v102
    v_and_b32 v103, 0xffff0000, v93
    v_fmac_f32 v19, v99, v103
    v_lshlrev_b32 v100, 16, v94
    v_fmac_f32 v20, v99, v100
    v_and_b32 v101, 0xffff0000, v94
    v_fmac_f32 v21, v99, v101
    v_lshlrev_b32 v102, 16, v95
    v_fmac_f32 v22, v99, v102
    v_and_b32 v103, 0xffff0000, v95
    v_fmac_f32 v23, v99, v103
    global_load_dwordx4 v[80:83], v1, s[6:7] offset:0 nt
    global_load_dwordx4 v[84:87], v1, s[6:7] offset:1024 nt
    global_load_dwordx4 v[88:91], v1, s[6:7] offset:2048 nt
    global_load_dwordx4 v[92:95], v1, s[6:7] offset:3072 nt
    v_add_u32 v1, 0x1000, v1
    v_and_b32 v1, 0x7fff, v1
    s_waitcnt vmcnt(12)
    v_lshlrev_b32 v100, 16, v32
    v_mul_f32 v96, v8, v100
    v_lshlrev_b32 v101, 16, v36
    v_mul_f32 v97, v8, v101
    v_lshlrev_b32 v102, 16, v40
    v_mul_f32 v98, v8, v102
    v_lshlrev_b32 v103, 16, v44
    v_mul_f32 v99, v8, v103
    v_and_b32 v100, 0xffff0000, v32
    v_fmac_f32 v96, v9, v100
    v_and_b32 v101, 0xffff0000, v36
    v_fmac_f32 v97, v9, v101
    v_and_b32 v102, 0xffff0000, v40
    v_fmac_f32 v98, v9, v102
    v_and_b32 v103, 0xffff0000, v44
    v_fmac_f32 v99, v9, v103
    v_lshlrev_b32 v100, 16, v33
    v_fmac_f32 v96, v10, v100
    v_lshlrev_b32 v101, 16, v37
    v_fmac_f32 v97, v10, v101
    v_lshlrev_b32 v102, 16, v41
    v_fmac_f32 v98, v10, v102
    v_lshlrev_b32 v103, 16, v45
    v_fmac_f32 v99, v10, v103
    v_and_b32 v100, 0xffff0000, v33
    v_fmac_f32 v96, v11, v100
    v_and_b32 v101, 0xffff0000, v37
    v_fmac_f32 v97, v11, v101
    v_and_b32 v102, 0xffff0000, v41
    v_fmac_f32 v98, v11, v102
    v_and_b32 v103, 0xffff0000, v45
    v_fmac_f32 v99, v11, v103
    v_lshlrev_b32 v100, 16, v34
    v_fmac_f32 v96, v12, v100
    v_lshlrev_b32 v101, 16, v38
    v_fmac_f32 v97, v12, v101
    v_lshlrev_b32 v102, 16, v42
    v_fmac_f32 v98, v12, v102
    v_lshlrev_b32 v103, 16, v46
    v_fmac_f32 v99, v12, v103
    v_and_b32 v100, 0xffff0000, v34
    v_fmac_f32 v96, v13, v100
    v_and_b32 v101, 0xffff0000, v38
    v_fmac_f32 v97, v13, v101
    v_and_b32 v102, 0xffff0000, v42
    v_fmac_f32 v98, v13, v102
    v_and_b32 v103, 0xffff0000, v46
    v_fmac_f32 v99, v13, v103
    v_lshlrev_b32 v100, 16, v35
    v_fmac_f32 v96, v14, v100
    v_lshlrev_b32 v101, 16, v39
    v_fmac_f32 v97, v14, v101
    v_lshlrev_b32 v102, 16, v43
    v_fmac_f32 v98, v14, v102
    v_lshlrev_b32 v103, 16, v47
    v_fmac_f32 v99, v14, v103
    v_and_b32 v100, 0xffff0000, v35
    v_fmac_f32 v96, v15, v100
    v_and_b32 v101, 0xffff0000, v39
    v_fmac_f32 v97, v15, v101
    v_and_b32 v102, 0xffff0000, v43
    v_fmac_f32 v98, v15, v102
    v_and_b32 v103, 0xffff0000, v47
    v_fmac_f32 v99, v15, v103
    v_add_f32_dpp v96, v96, v96 quad_perm:[1,0,3,2] row_mask:0xf bank_mask:0xf
    v_add_f32_dpp v97, v97, v97 quad_perm:[1,0,3,2] row_mask:0xf bank_mask:0xf
    v_add_f32_dpp v98, v98, v98 quad_perm:[1,0,3,2] row_mask:0xf bank_mask:0xf
    v_add_f32_dpp v99, v99, v99 quad_perm:[1,0,3,2] row_mask:0xf bank_mask:0xf
    v_add_f32_dpp v96, v96, v96 quad_perm:[2,3,0,1] row_mask:0xf bank_mask:0xf
    v_add_f32_dpp v97, v97, v97 quad_perm:[2,3,0,1] row_mask:0xf bank_mask:0xf
    v_add_f32_dpp v98, v98, v98 quad_perm:[2,3,0,1] row_mask:0xf bank_mask:0xf
    v_add_f32_dpp v99, v99, v99 quad_perm:[2,3,0,1] row_mask:0xf bank_mask:0xf
    v_add_f32_dpp v96, v96, v96 row_half_mirror row_mask:0xf bank_mask:0xf
    v_add_f32_dpp v97, v97, v97 row_half_mirror row_mask:0xf bank_mask:0xf
    v_add_f32_dpp v98, v98, v98 row_half_mirror row_mask:0xf bank_mask:0xf
    v_add_f32_dpp v99, v99, v99 row_half_mirror row_mask:0xf bank_mask:0xf
    v_add_f32_dpp v96, v96, v96 row_mirror row_mask:0xf bank_mask:0xf
    v_add_f32_dpp v97, v97, v97 row_mirror row_mask:0xf bank_mask:0xf
    v_add_f32_dpp v98, v98, v98 row_mirror row_mask:0xf bank_mask:0xf
    v_add_f32_dpp v99, v99, v99 row_mirror row_mask:0xf bank_mask:0xf
    v_max3_f32 v104, v96, v97, v24
    v_max3_f32 v104, v98, v99, v104
    v_sub_f32 v105, v24, v104
    v_exp_f32 v105, v105
    v_sub_f32 v96, v96, v104
    v_sub_f32 v97, v97, v104
    v_sub_f32 v98, v98, v104
    v_sub_f32 v99, v99, v104
    v_exp_f32 v96, v96
    v_exp_f32 v97, v97
    v_exp_f32 v98, v98
    v_exp_f32 v99, v99
    v_mov_b32 v24, v104
    v_mul_f32 v25, v25, v105
    v_mul_f32 v16, v16, v105
    v_mul_f32 v17, v17, v105
    v_mul_f32 v18, v18, v105
    v_mul_f32 v19, v19, v105
    v_mul_f32 v20, v20, v105
    v_mul_f32 v21, v21, v105
    v_mul_f32 v22, v22, v105
    v_mul_f32 v23, v23, v105
    v_add_f32 v25, v25, v96
    v_add_f32 v25, v25, v97
    v_add_f32 v25, v25, v98
    v_add_f32 v25, v25, v99
    s_waitcnt vmcnt(8)
    v_lshlrev_b32 v100, 16, v64
    v_fmac_f32 v16, v96, v100
    v_and_b32 v101, 0xffff0000, v64
    v_fmac_f32 v17, v96, v101
    v_lshlrev_b32 v102, 16, v65
    v_fmac_f32 v18, v96, v102
    v_and_b32 v103, 0xffff0000, v65
    v_fmac_f32 v19, v96, v103
    v_lshlrev_b32 v100, 16, v66
    v_fmac_f32 v20, v96, v100
    v_and_b32 v101, 0xffff0000, v66
    v_fmac_f32 v21, v96, v101
    v_lshlrev_b32 v102, 16, v67
    v_fmac_f32 v22, v96, v102
    v_and_b32 v103, 0xffff0000, v67
    v_fmac_f32 v23, v96, v103
    v_lshlrev_b32 v100, 16, v68
    v_fmac_f32 v16, v97, v100
    v_and_b32 v101, 0xffff0000, v68
    v_fmac_f32 v17, v97, v101
    v_lshlrev_b32 v102, 16, v69
    v_fmac_f32 v18, v97, v102
    v_and_b32 v103, 0xffff0000, v69
    v_fmac_f32 v19, v97, v103
    v_lshlrev_b32 v100, 16, v70
    v_fmac_f32 v20, v97, v100
    v_and_b32 v101, 0xffff0000, v70
    v_fmac_f32 v21, v97, v101
    v_lshlrev_b32 v102, 16, v71
    v_fmac_f32 v22, v97, v102
    v_and_b32 v103, 0xffff0000, v71
    v_fmac_f32 v23, v97, v103
    v_lshlrev_b32 v100, 16, v72
    v_fmac_f32 v16, v98, v100
    v_and_b32 v101, 0xffff0000, v72
    v_fmac_f32 v17, v98, v101
    v_lshlrev_b32 v102, 16, v73
    v_fmac_f32 v18, v98, v102
    v_and_b32 v103, 0xffff0000, v73
    v_fmac_f32 v19, v98, v103
    v_lshlrev_b32 v100, 16, v74
    v_fmac_f32 v20, v98, v100
    v_and_b32 v101, 0xffff0000, v74
    v_fmac_f32 v21, v98, v101
    v_lshlrev_b32 v102, 16, v75
    v_fmac_f32 v22, v98, v102
    v_and_b32 v103, 0xffff0000, v75
    v_fmac_f32 v23, v98, v103
    v_lshlrev_b32 v100, 16, v76
    v_fmac_f32 v16, v99, v100
    v_and_b32 v101, 0xffff0000, v76
    v_fmac_f32 v17, v99, v101
    v_lshlrev_b32 v102, 16, v77
    v_fmac_f32 v18, v99, v102
    v_and_b32 v103, 0xffff0000, v77
    v_fmac_f32 v19, v99, v103
    v_lshlrev_b32 v100, 16, v78
    v_fmac_f32 v20, v99, v100
    v_and_b32 v101, 0xffff0000, v78
    v_fmac_f32 v21, v99, v101
    v_lshlrev_b32 v102, 16, v79
    v_fmac_f32 v22, v99, v102
    v_and_b32 v103, 0xffff0000, v79
    v_fmac_f32 v23, v99, v103
    s_waitcnt vmcnt(4)
    v_lshlrev_b32 v100, 16, v48
    v_mul_f32 v96, v8, v100
    v_lshlrev_b32 v101, 16, v52
    v_mul_f32 v97, v8, v101
    v_lshlrev_b32 v102, 16, v56
    v_mul_f32 v98, v8, v102
    v_lshlrev_b32 v103, 16, v60
    v_mul_f32 v99, v8, v103
    v_and_b32 v100, 0xffff0000, v48
    v_fmac_f32 v96, v9, v100
    v_and_b32 v101, 0xffff0000, v52
    v_fmac_f32 v97, v9, v101
    v_and_b32 v102, 0xffff0000, v56
    v_fmac_f32 v98, v9, v102
    v_and_b32 v103, 0xffff0000, v60
    v_fmac_f32 v99, v9, v103
    v_lshlrev_b32 v100, 16, v49
    v_fmac_f32 v96, v10, v100
    v_lshlrev_b32 v101, 16, v53
    v_fmac_f32 v97, v10, v101
    v_lshlrev_b32 v102, 16, v57
    v_fmac_f32 v98, v10, v102
    v_lshlrev_b32 v103, 16, v61
    v_fmac_f32 v99, v10, v103
    v_and_b32 v100, 0xffff0000, v49
    v_fmac_f32 v96, v11, v100
    v_and_b32 v101, 0xffff0000, v53
    v_fmac_f32 v97, v11, v101
    v_and_b32 v102, 0xffff0000, v57
    v_fmac_f32 v98, v11, v102
    v_and_b32 v103, 0xffff0000, v61
    v_fmac_f32 v99, v11, v103
    v_lshlrev_b32 v100, 16, v50
    v_fmac_f32 v96, v12, v100
    v_lshlrev_b32 v101, 16, v54
    v_fmac_f32 v97, v12, v101
    v_lshlrev_b32 v102, 16, v58
    v_fmac_f32 v98, v12, v102
    v_lshlrev_b32 v103, 16, v62
    v_fmac_f32 v99, v12, v103
    v_and_b32 v100, 0xffff0000, v50
    v_fmac_f32 v96, v13, v100
    v_and_b32 v101, 0xffff0000, v54
    v_fmac_f32 v97, v13, v101
    v_and_b32 v102, 0xffff0000, v58
    v_fmac_f32 v98, v13, v102
    v_and_b32 v103, 0xffff0000, v62
    v_fmac_f32 v99, v13, v103
    v_lshlrev_b32 v100, 16, v51
    v_fmac_f32 v96, v14, v100
    v_lshlrev_b32 v101, 16, v55
    v_fmac_f32 v97, v14, v101
    v_lshlrev_b32 v102, 16, v59
    v_fmac_f32 v98, v14, v102
    v_lshlrev_b32 v103, 16, v63
    v_fmac_f32 v99, v14, v103
    v_and_b32 v100, 0xffff0000, v51
    v_fmac_f32 v96, v15, v100
    v_and_b32 v101, 0xffff0000, v55
    v_fmac_f32 v97, v15, v101
    v_and_b32 v102, 0xffff0000, v59
    v_fmac_f32 v98, v15, v102
    v_and_b32 v103, 0xffff0000, v63
    v_fmac_f32 v99, v15, v103
    v_add_f32_dpp v96, v96, v96 quad_perm:[1,0,3,2] row_mask:0xf bank_mask:0xf
    v_add_f32_dpp v97, v97, v97 quad_perm:[1,0,3,2] row_mask:0xf bank_mask:0xf
    v_add_f32_dpp v98, v98, v98 quad_perm:[1,0,3,2] row_mask:0xf bank_mask:0xf
    v_add_f32_dpp v99, v99, v99 quad_perm:[1,0,3,2] row_mask:0xf bank_mask:0xf
    v_add_f32_dpp v96, v96, v96 quad_perm:[2,3,0,1] row_mask:0xf bank_mask:0xf
    v_add_f32_dpp v97, v97, v97 quad_perm:[2,3,0,1] row_mask:0xf bank_mask:0xf
    v_add_f32_dpp v98, v98, v98 quad_perm:[2,3,0,1] row_mask:0xf bank_mask:0xf
    v_add_f32_dpp v99, v99, v99 quad_perm:[2,3,0,1] row_mask:0xf bank_mask:0xf
    v_add_f32_dpp v96, v96, v96 row_half_mirror row_mask:0xf bank_mask:0xf
    v_add_f32_dpp v97, v97, v97 row_half_mirror row_mask:0xf bank_mask:0xf
    v_add_f32_dpp v98, v98, v98 row_half_mirror row_mask:0xf bank_mask:0xf
    v_add_f32_dpp v99, v99, v99 row_half_mirror row_mask:0xf bank_mask:0xf
    v_add_f32_dpp v96, v96, v96 row_mirror row_mask:0xf bank_mask:0xf
    v_add_f32_dpp v97, v97, v97 row_mirror row_mask:0xf bank_mask:0xf
    v_add_f32_dpp v98, v98, v98 row_mirror row_mask:0xf bank_mask:0xf
    v_add_f32_dpp v99, v99, v99 row_mirror row_mask:0xf bank_mask:0xf
    v_max3_f32 v104, v96, v97, v24
    v_max3_f32 v104, v98, v99, v104
    v_sub_f32 v105, v24, v104
    v_exp_f32 v105, v105
    v_sub_f32 v96, v96, v104
    v_sub_f32 v97, v97, v104
    v_sub_f32 v98, v98, v104
    v_sub_f32 v99, v99, v104
    v_exp_f32 v96, v96
    v_exp_f32 v97, v97
    v_exp_f32 v98, v98
    v_exp_f32 v99, v99
    v_mov_b32 v24, v104
    v_mul_f32 v25, v25, v105
    v_mul_f32 v16, v16, v105
    v_mul_f32 v17, v17, v105
    v_mul_f32 v18, v18, v105
    v_mul_f32 v19, v19, v105
    v_mul_f32 v20, v20, v105
    v_mul_f32 v21, v21, v105
    v_mul_f32 v22, v22, v105
    v_mul_f32 v23, v23, v105
    v_add_f32 v25, v25, v96
    v_add_f32 v25, v25, v97
    v_add_f32 v25, v25, v98
    v_add_f32 v25, v25, v99
    s_waitcnt vmcnt(0)
    v_lshlrev_b32 v100, 16, v80
    v_fmac_f32 v16, v96, v100
    v_and_b32 v101, 0xffff0000, v80
    v_fmac_f32 v17, v96, v101
    v_lshlrev_b32 v102, 16, v81
    v_fmac_f32 v18, v96, v102
    v_and_b32 v103, 0xffff0000, v81
    v_fmac_f32 v19, v96, v103
    v_lshlrev_b32 v100, 16, v82
    v_fmac_f32 v20, v96, v100
    v_and_b32 v101, 0xffff0000, v82
    v_fmac_f32 v21, v96, v101
    v_lshlrev_b32 v102, 16, v83
    v_fmac_f32 v22, v96, v102
    v_and_b32 v103, 0xffff0000, v83
    v_fmac_f32 v23, v96, v103
    v_lshlrev_b32 v100, 16, v84
    v_fmac_f32 v16, v97, v100
    v_and_b32 v101, 0xffff0000, v84
    v_fmac_f32 v17, v97, v101
    v_lshlrev_b32 v102, 16, v85
    v_fmac_f32 v18, v97, v102
    v_and_b32 v103, 0xffff0000, v85
    v_fmac_f32 v19, v97, v103
    v_lshlrev_b32 v100, 16, v86
    v_fmac_f32 v20, v97, v100
    v_and_b32 v101, 0xffff0000, v86
    v_fmac_f32 v21, v97, v101
    v_lshlrev_b32 v102, 16, v87
    v_fmac_f32 v22, v97, v102
    v_and_b32 v103, 0xffff0000, v87
    v_fmac_f32 v23, v97, v103
    v_lshlrev_b32 v100, 16, v88
    v_fmac_f32 v16, v98, v100
    v_and_b32 v101, 0xffff0000, v88
    v_fmac_f32 v17, v98, v101
    v_lshlrev_b32 v102, 16, v89
    v_fmac_f32 v18, v98, v102
    v_and_b32 v103, 0xffff0000, v89
    v_fmac_f32 v19, v98, v103
    v_lshlrev_b32 v100, 16, v90
    v_fmac_f32 v20, v98, v100
    v_and_b32 v101, 0xffff0000, v90
    v_fmac_f32 v21, v98, v101
    v_lshlrev_b32 v102, 16, v91
    v_fmac_f32 v22, v98, v102
    v_and_b32 v103, 0xffff0000, v91
    v_fmac_f32 v23, v98, v103
    v_lshlrev_b32 v100, 16, v92
    v_fmac_f32 v16, v99, v100
    v_and_b32 v101, 0xffff0000, v92
    v_fmac_f32 v17, v99, v101
    v_lshlrev_b32 v102, 16, v93
    v_fmac_f32 v18, v99, v102
    v_and_b32 v103, 0xffff0000, v93
    v_fmac_f32 v19, v99, v103
    v_lshlrev_b32 v100, 16, v94
    v_fmac_f32 v20, v99, v100
    v_and_b32 v101, 0xffff0000, v94
    v_fmac_f32 v21, v99, v101
    v_lshlrev_b32 v102, 16, v95
    v_fmac_f32 v22, v99, v102
    v_and_b32 v103, 0xffff0000, v95
    v_fmac_f32 v23, v99, v103
    v_lshrrev_b32 v2, 4, v0
    v_and_b32 v3, 15, v0
    v_lshlrev_b32 v4, 9, v2
    v_lshl_add_u32 v4, v3, 5, v4
    ds_write_b128 v4, v[16:19]
    ds_write_b128 v4, v[20:23] offset:16
    v_lshlrev_b32 v4, 3, v2
    v_cmp_eq_u32 vcc, 0, v3
    s_and_saveexec_b64 s[30:31], vcc
    ds_write_b64 v4, v[24:25] offset:8192
    s_mov_b64 exec, s[30:31]
    s_waitcnt lgkmcnt(0)
    s_barrier
    v_cmp_gt_u32 vcc, 128, v0
    s_and_saveexec_b64 s[30:31], vcc
    s_cbranch_execz k3_end
    v_mov_b32 v4, 0
    ds_read_b64 v[32:33], v4 offset:8192
    ds_read_b64 v[34:35], v4 offset:8200
    ds_read_b64 v[36:37], v4 offset:8208
    ds_read_b64 v[38:39], v4 offset:8216
    ds_read_b64 v[40:41], v4 offset:8224
    ds_read_b64 v[42:43], v4 offset:8232
    ds_read_b64 v[44:45], v4 offset:8240
    ds_read_b64 v[46:47], v4 offset:8248
    ds_read_b64 v[48:49], v4 offset:8256
    ds_read_b64 v[50:51], v4 offset:8264
    ds_read_b64 v[52:53], v4 offset:8272
    ds_read_b64 v[54:55], v4 offset:8280
    ds_read_b64 v[56:57], v4 offset:8288
    ds_read_b64 v[58:59], v4 offset:8296
    ds_read_b64 v[60:61], v4 offset:8304
    ds_read_b64 v[62:63], v4 offset:8312
    v_lshlrev_b32 v5, 2, v0
    ds_read_b32 v64, v5 offset:0
    ds_read_b32 v65, v5 offset:512
    ds_read_b32 v66, v5 offset:1024
    ds_read_b32 v67, v5 offset:1536
    ds_read_b32 v68, v5 offset:2048
    ds_read_b32 v69, v5 offset:2560
    ds_read_b32 v70, v5 offset:3072
    ds_read_b32 v71, v5 offset:3584
    ds_read_b32 v72, v5 offset:4096
    ds_read_b32 v73, v5 offset:4608
    ds_read_b32 v74, v5 offset:5120
    ds_read_b32 v75, v5 offset:5632
    ds_read_b32 v76, v5 offset:6144
    ds_read_b32 v77, v5 offset:6656
    ds_read_b32 v78, v5 offset:7168
    ds_read_b32 v79, v5 offset:7680
    s_waitcnt lgkmcnt(0)
    v_max_f32 v8, v32, v34
    v_max_f32 v8, v8, v36
    v_max_f32 v8, v8, v38
    v_max_f32 v8, v8, v40
    v_max_f32 v8, v8, v42
    v_max_f32 v8, v8, v44
    v_max_f32 v8, v8, v46
    v_max_f32 v8, v8, v48
    v_max_f32 v8, v8, v50
    v_max_f32 v8, v8, v52
    v_max_f32 v8, v8, v54
    v_max_f32 v8, v8, v56
    v_max_f32 v8, v8, v58
    v_max_f32 v8, v8, v60
    v_max_f32 v8, v8, v62
    v_sub_f32 v32, v32, v8
    v_sub_f32 v34, v34, v8
    v_sub_f32 v36, v36, v8
    v_sub_f32 v38, v38, v8
    v_sub_f32 v40, v40, v8
    v_sub_f32 v42, v42, v8
    v_sub_f32 v44, v44, v8
    v_sub_f32 v46, v46, v8
    v_sub_f32 v48, v48, v8
    v_sub_f32 v50, v50, v8
    v_sub_f32 v52, v52, v8
    v_sub_f32 v54, v54, v8
    v_sub_f32 v56, v56, v8
    v_sub_f32 v58, v58, v8
    v_sub_f32 v60, v60, v8
    v_sub_f32 v62, v62, v8
    v_exp_f32 v32, v32
    v_exp_f32 v34, v34
    v_exp_f32 v36, v36
    v_exp_f32 v38, v38
    v_exp_f32 v40, v40
    v_exp_f32 v42, v42
    v_exp_f32 v44, v44
    v_exp_f32 v46, v46
    v_exp_f32 v48, v48
    v_exp_f32 v50, v50
    v_exp_f32 v52, v52
    v_exp_f32 v54, v54
    v_exp_f32 v56, v56
    v_exp_f32 v58, v58
    v_exp_f32 v60, v60
    v_exp_f32 v62, v62
    v_mov_b32 v9, 0
    v_mov_b32 v10, 0
    v_fmac_f32 v9, v32, v33
    v_fmac_f32 v10, v32, v64
    v_fmac_f32 v9, v34, v35
    v_fmac_f32 v10, v34, v65
    v_fmac_f32 v9, v36, v37
    v_fmac_f32 v10, v36, v66
    v_fmac_f32 v9, v38, v39
    v_fmac_f32 v10, v38, v67
    v_fmac_f32 v9, v40, v41
    v_fmac_f32 v10, v40, v68
    v_fmac_f32 v9, v42, v43
    v_fmac_f32 v10, v42, v69
    v_fmac_f32 v9, v44, v45
    v_fmac_f32 v10, v44, v70
    v_fmac_f32 v9, v46, v47
    v_fmac_f32 v10, v46, v71
    v_fmac_f32 v9, v48, v49
    v_fmac_f32 v10, v48, v72
    v_fmac_f32 v9, v50, v51
    v_fmac_f32 v10, v50, v73
    v_fmac_f32 v9, v52, v53
    v_fmac_f32 v10, v52, v74
    v_fmac_f32 v9, v54, v55
    v_fmac_f32 v10, v54, v75
    v_fmac_f32 v9, v56, v57
    v_fmac_f32 v10, v56, v76
    v_fmac_f32 v9, v58, v59
    v_fmac_f32 v10, v58, v77
    v_fmac_f32 v9, v60, v61
    v_fmac_f32 v10, v60, v78
    v_fmac_f32 v9, v62, v63
    v_fmac_f32 v10, v62, v79
    s_mul_i32 s25, s2, 528
    s_add_u32 s25, s25, 524288
    s_add_u32 s26, s8, s25
    s_addc_u32 s27, s9, 0
    global_store_dword v5, v10, s[26:27] offset:16
    v_cmp_eq_u32 vcc, 0, v0
    s_and_saveexec_b64 s[28:29], vcc
    global_store_dwordx2 v4, v[8:9], s[26:27]
k3_end:
    s_endpgm
.globl k4_wo_kernel
.p2align 8
.type k4_wo_kernel,@function
k4_wo_kernel:
    s_load_dwordx2 s[6:7], s[0:1], 32
    s_load_dwordx2 s[8:9], s[0:1], 104
    s_cmp_ge_u32 s2, 64
    s_cbranch_scc1 k4_end
    s_lshr_b32 s20, s2, 1
    s_and_b32 s21, s2, 1
    s_waitcnt lgkmcnt(0)
    v_mul_u32_u24 v1, 911, v0
    v_lshrrev_b32 v1, 16, v1
    v_mul_u32_u24 v2, 72, v1
    v_sub_u32 v2, v0, v2
    s_lshl_b32 s22, s2, 6
    s_mul_i32 s22, s22, 1152
    s_add_u32 s6, s6, s22
    s_addc_u32 s7, s7, 0
    v_lshlrev_b32 v3, 4, v0
    v_lshrrev_b32 v4, 6, v0
    v_and_b32 v5, 63, v0
    v_cmp_gt_u32 vcc, 256, v0
    s_and_saveexec_b64 s[30:31], vcc
    s_cbranch_execz k4_skip1
    v_mul_u32_u24 v6, 135168, v4
    s_mul_i32 s23, s20, 4224
    s_add_u32 s23, s23, 524288
    s_add_u32 s24, s8, s23
    s_addc_u32 s25, s9, 0
    s_lshl_b32 s26, s21, 8
    v_lshl_add_u32 v7, v5, 2, v6
    v_add_u32 v7, s26, v7
    global_load_dwordx2 v[32:33], v6, s[24:25] offset:0
    global_load_dword v48, v7, s[24:25] offset:16
    global_load_dwordx2 v[34:35], v6, s[24:25] offset:528
    global_load_dword v49, v7, s[24:25] offset:544
    global_load_dwordx2 v[36:37], v6, s[24:25] offset:1056
    global_load_dword v50, v7, s[24:25] offset:1072
    global_load_dwordx2 v[38:39], v6, s[24:25] offset:1584
    global_load_dword v51, v7, s[24:25] offset:1600
    global_load_dwordx2 v[40:41], v6, s[24:25] offset:2112
    global_load_dword v52, v7, s[24:25] offset:2128
    global_load_dwordx2 v[42:43], v6, s[24:25] offset:2640
    global_load_dword v53, v7, s[24:25] offset:2656
    global_load_dwordx2 v[44:45], v6, s[24:25] offset:3168
    global_load_dword v54, v7, s[24:25] offset:3184
    global_load_dwordx2 v[46:47], v6, s[24:25] offset:3696
    global_load_dword v55, v7, s[24:25] offset:3712
    s_waitcnt vmcnt(0)
    v_max_f32 v8, v32, v34
    v_max_f32 v8, v8, v36
    v_max_f32 v8, v8, v38
    v_max_f32 v8, v8, v40
    v_max_f32 v8, v8, v42
    v_max_f32 v8, v8, v44
    v_max_f32 v8, v8, v46
    v_sub_f32 v32, v32, v8
    v_sub_f32 v34, v34, v8
    v_sub_f32 v36, v36, v8
    v_sub_f32 v38, v38, v8
    v_sub_f32 v40, v40, v8
    v_sub_f32 v42, v42, v8
    v_sub_f32 v44, v44, v8
    v_sub_f32 v46, v46, v8
    v_exp_f32 v32, v32
    v_exp_f32 v34, v34
    v_exp_f32 v36, v36
    v_exp_f32 v38, v38
    v_exp_f32 v40, v40
    v_exp_f32 v42, v42
    v_exp_f32 v44, v44
    v_exp_f32 v46, v46
    v_mov_b32 v9, 0
    v_mov_b32 v10, 0
    v_fmac_f32 v9, v32, v33
    v_fmac_f32 v10, v32, v48
    v_fmac_f32 v9, v34, v35
    v_fmac_f32 v10, v34, v49
    v_fmac_f32 v9, v36, v37
    v_fmac_f32 v10, v36, v50
    v_fmac_f32 v9, v38, v39
    v_fmac_f32 v10, v38, v51
    v_fmac_f32 v9, v40, v41
    v_fmac_f32 v10, v40, v52
    v_fmac_f32 v9, v42, v43
    v_fmac_f32 v10, v42, v53
    v_fmac_f32 v9, v44, v45
    v_fmac_f32 v10, v44, v54
    v_fmac_f32 v9, v46, v47
    v_fmac_f32 v10, v46, v55
    v_rcp_f32 v9, v9
    s_nop 0
    v_mul_f32 v10, v10, v9
    v_lshlrev_b32 v6, 4, v5
    v_lshl_add_u32 v6, v4, 2, v6
    ds_write_b32 v6, v10
k4_skip1:
    s_mov_b64 exec, s[30:31]
    global_load_dwordx4 v[64:67], v3, s[6:7] nt
    s_add_u32 s6, s6, 4608
    s_addc_u32 s7, s7, 0
    global_load_dwordx4 v[68:71], v3, s[6:7] nt
    s_add_u32 s6, s6, 4608
    s_addc_u32 s7, s7, 0
    global_load_dwordx4 v[72:75], v3, s[6:7] nt
    s_add_u32 s6, s6, 4608
    s_addc_u32 s7, s7, 0
    global_load_dwordx4 v[76:79], v3, s[6:7] nt
    s_add_u32 s6, s6, 4608
    s_addc_u32 s7, s7, 0
    global_load_dwordx4 v[80:83], v3, s[6:7] nt
    s_add_u32 s6, s6, 4608
    s_addc_u32 s7, s7, 0
    global_load_dwordx4 v[84:87], v3, s[6:7] nt
    s_add_u32 s6, s6, 4608
    s_addc_u32 s7, s7, 0
    global_load_dwordx4 v[88:91], v3, s[6:7] nt
    s_add_u32 s6, s6, 4608
    s_addc_u32 s7, s7, 0
    global_load_dwordx4 v[92:95], v3, s[6:7] nt
    s_add_u32 s6, s6, 4608
    s_addc_u32 s7, s7, 0
    global_load_dwordx4 v[96:99], v3, s[6:7] nt
    s_add_u32 s6, s6, 4608
    s_addc_u32 s7, s7, 0
    global_load_dwordx4 v[100:103], v3, s[6:7] nt
    s_add_u32 s6, s6, 4608
    s_addc_u32 s7, s7, 0
    global_load_dwordx4 v[104:107], v3, s[6:7] nt
    s_add_u32 s6, s6, 4608
    s_addc_u32 s7, s7, 0
    global_load_dwordx4 v[108:111], v3, s[6:7] nt
    s_add_u32 s6, s6, 4608
    s_addc_u32 s7, s7, 0
    global_load_dwordx4 v[112:115], v3, s[6:7] nt
    s_add_u32 s6, s6, 4608
    s_addc_u32 s7, s7, 0
    global_load_dwordx4 v[116:119], v3, s[6:7] nt
    s_add_u32 s6, s6, 4608
    s_addc_u32 s7, s7, 0
    global_load_dwordx4 v[120:123], v3, s[6:7] nt
    s_add_u32 s6, s6, 4608
    s_addc_u32 s7, s7, 0
    global_load_dwordx4 v[124:127], v3, s[6:7] nt
    s_waitcnt lgkmcnt(0)
    s_barrier
    v_lshlrev_b32 v4, 4, v1
    ds_read_b128 v[160:163], v4 offset:0
    ds_read_b128 v[164:167], v4 offset:64
    ds_read_b128 v[168:171], v4 offset:128
    ds_read_b128 v[172:175], v4 offset:192
    ds_read_b128 v[176:179], v4 offset:256
    ds_read_b128 v[180:183], v4 offset:320
    ds_read_b128 v[184:187], v4 offset:384
    ds_read_b128 v[188:191], v4 offset:448
    ds_read_b128 v[192:195], v4 offset:512
    ds_read_b128 v[196:199], v4 offset:576
    ds_read_b128 v[200:203], v4 offset:640
    ds_read_b128 v[204:207], v4 offset:704
    ds_read_b128 v[208:211], v4 offset:768
    ds_read_b128 v[212:215], v4 offset:832
    ds_read_b128 v[216:219], v4 offset:896
    ds_read_b128 v[220:223], v4 offset:960
    s_waitcnt lgkmcnt(0)
    s_waitcnt vmcnt(15)
    v_lshlrev_b32 v250, 16, v64
    v_and_b32 v251, 0xffff0000, v64
    v_mul_f32 v128, v160, v250
    v_mul_f32 v129, v160, v251
    v_mul_f32 v136, v161, v250
    v_mul_f32 v137, v161, v251
    v_mul_f32 v144, v162, v250
    v_mul_f32 v145, v162, v251
    v_mul_f32 v152, v163, v250
    v_mul_f32 v153, v163, v251
    v_lshlrev_b32 v250, 16, v65
    v_and_b32 v251, 0xffff0000, v65
    v_mul_f32 v130, v160, v250
    v_mul_f32 v131, v160, v251
    v_mul_f32 v138, v161, v250
    v_mul_f32 v139, v161, v251
    v_mul_f32 v146, v162, v250
    v_mul_f32 v147, v162, v251
    v_mul_f32 v154, v163, v250
    v_mul_f32 v155, v163, v251
    v_lshlrev_b32 v250, 16, v66
    v_and_b32 v251, 0xffff0000, v66
    v_mul_f32 v132, v160, v250
    v_mul_f32 v133, v160, v251
    v_mul_f32 v140, v161, v250
    v_mul_f32 v141, v161, v251
    v_mul_f32 v148, v162, v250
    v_mul_f32 v149, v162, v251
    v_mul_f32 v156, v163, v250
    v_mul_f32 v157, v163, v251
    v_lshlrev_b32 v250, 16, v67
    v_and_b32 v251, 0xffff0000, v67
    v_mul_f32 v134, v160, v250
    v_mul_f32 v135, v160, v251
    v_mul_f32 v142, v161, v250
    v_mul_f32 v143, v161, v251
    v_mul_f32 v150, v162, v250
    v_mul_f32 v151, v162, v251
    v_mul_f32 v158, v163, v250
    v_mul_f32 v159, v163, v251
    s_waitcnt vmcnt(14)
    v_lshlrev_b32 v250, 16, v68
    v_and_b32 v251, 0xffff0000, v68
    v_fmac_f32 v128, v164, v250
    v_fmac_f32 v129, v164, v251
    v_fmac_f32 v136, v165, v250
    v_fmac_f32 v137, v165, v251
    v_fmac_f32 v144, v166, v250
    v_fmac_f32 v145, v166, v251
    v_fmac_f32 v152, v167, v250
    v_fmac_f32 v153, v167, v251
    v_lshlrev_b32 v250, 16, v69
    v_and_b32 v251, 0xffff0000, v69
    v_fmac_f32 v130, v164, v250
    v_fmac_f32 v131, v164, v251
    v_fmac_f32 v138, v165, v250
    v_fmac_f32 v139, v165, v251
    v_fmac_f32 v146, v166, v250
    v_fmac_f32 v147, v166, v251
    v_fmac_f32 v154, v167, v250
    v_fmac_f32 v155, v167, v251
    v_lshlrev_b32 v250, 16, v70
    v_and_b32 v251, 0xffff0000, v70
    v_fmac_f32 v132, v164, v250
    v_fmac_f32 v133, v164, v251
    v_fmac_f32 v140, v165, v250
    v_fmac_f32 v141, v165, v251
    v_fmac_f32 v148, v166, v250
    v_fmac_f32 v149, v166, v251
    v_fmac_f32 v156, v167, v250
    v_fmac_f32 v157, v167, v251
    v_lshlrev_b32 v250, 16, v71
    v_and_b32 v251, 0xffff0000, v71
    v_fmac_f32 v134, v164, v250
    v_fmac_f32 v135, v164, v251
    v_fmac_f32 v142, v165, v250
    v_fmac_f32 v143, v165, v251
    v_fmac_f32 v150, v166, v250
    v_fmac_f32 v151, v166, v251
    v_fmac_f32 v158, v167, v250
    v_fmac_f32 v159, v167, v251
    s_waitcnt vmcnt(13)
    v_lshlrev_b32 v250, 16, v72
    v_and_b32 v251, 0xffff0000, v72
    v_fmac_f32 v128, v168, v250
    v_fmac_f32 v129, v168, v251
    v_fmac_f32 v136, v169, v250
    v_fmac_f32 v137, v169, v251
    v_fmac_f32 v144, v170, v250
    v_fmac_f32 v145, v170, v251
    v_fmac_f32 v152, v171, v250
    v_fmac_f32 v153, v171, v251
    v_lshlrev_b32 v250, 16, v73
    v_and_b32 v251, 0xffff0000, v73
    v_fmac_f32 v130, v168, v250
    v_fmac_f32 v131, v168, v251
    v_fmac_f32 v138, v169, v250
    v_fmac_f32 v139, v169, v251
    v_fmac_f32 v146, v170, v250
    v_fmac_f32 v147, v170, v251
    v_fmac_f32 v154, v171, v250
    v_fmac_f32 v155, v171, v251
    v_lshlrev_b32 v250, 16, v74
    v_and_b32 v251, 0xffff0000, v74
    v_fmac_f32 v132, v168, v250
    v_fmac_f32 v133, v168, v251
    v_fmac_f32 v140, v169, v250
    v_fmac_f32 v141, v169, v251
    v_fmac_f32 v148, v170, v250
    v_fmac_f32 v149, v170, v251
    v_fmac_f32 v156, v171, v250
    v_fmac_f32 v157, v171, v251
    v_lshlrev_b32 v250, 16, v75
    v_and_b32 v251, 0xffff0000, v75
    v_fmac_f32 v134, v168, v250
    v_fmac_f32 v135, v168, v251
    v_fmac_f32 v142, v169, v250
    v_fmac_f32 v143, v169, v251
    v_fmac_f32 v150, v170, v250
    v_fmac_f32 v151, v170, v251
    v_fmac_f32 v158, v171, v250
    v_fmac_f32 v159, v171, v251
    s_waitcnt vmcnt(12)
    v_lshlrev_b32 v250, 16, v76
    v_and_b32 v251, 0xffff0000, v76
    v_fmac_f32 v128, v172, v250
    v_fmac_f32 v129, v172, v251
    v_fmac_f32 v136, v173, v250
    v_fmac_f32 v137, v173, v251
    v_fmac_f32 v144, v174, v250
    v_fmac_f32 v145, v174, v251
    v_fmac_f32 v152, v175, v250
    v_fmac_f32 v153, v175, v251
    v_lshlrev_b32 v250, 16, v77
    v_and_b32 v251, 0xffff0000, v77
    v_fmac_f32 v130, v172, v250
    v_fmac_f32 v131, v172, v251
    v_fmac_f32 v138, v173, v250
    v_fmac_f32 v139, v173, v251
    v_fmac_f32 v146, v174, v250
    v_fmac_f32 v147, v174, v251
    v_fmac_f32 v154, v175, v250
    v_fmac_f32 v155, v175, v251
    v_lshlrev_b32 v250, 16, v78
    v_and_b32 v251, 0xffff0000, v78
    v_fmac_f32 v132, v172, v250
    v_fmac_f32 v133, v172, v251
    v_fmac_f32 v140, v173, v250
    v_fmac_f32 v141, v173, v251
    v_fmac_f32 v148, v174, v250
    v_fmac_f32 v149, v174, v251
    v_fmac_f32 v156, v175, v250
    v_fmac_f32 v157, v175, v251
    v_lshlrev_b32 v250, 16, v79
    v_and_b32 v251, 0xffff0000, v79
    v_fmac_f32 v134, v172, v250
    v_fmac_f32 v135, v172, v251
    v_fmac_f32 v142, v173, v250
    v_fmac_f32 v143, v173, v251
    v_fmac_f32 v150, v174, v250
    v_fmac_f32 v151, v174, v251
    v_fmac_f32 v158, v175, v250
    v_fmac_f32 v159, v175, v251
    s_waitcnt vmcnt(11)
    v_lshlrev_b32 v250, 16, v80
    v_and_b32 v251, 0xffff0000, v80
    v_fmac_f32 v128, v176, v250
    v_fmac_f32 v129, v176, v251
    v_fmac_f32 v136, v177, v250
    v_fmac_f32 v137, v177, v251
    v_fmac_f32 v144, v178, v250
    v_fmac_f32 v145, v178, v251
    v_fmac_f32 v152, v179, v250
    v_fmac_f32 v153, v179, v251
    v_lshlrev_b32 v250, 16, v81
    v_and_b32 v251, 0xffff0000, v81
    v_fmac_f32 v130, v176, v250
    v_fmac_f32 v131, v176, v251
    v_fmac_f32 v138, v177, v250
    v_fmac_f32 v139, v177, v251
    v_fmac_f32 v146, v178, v250
    v_fmac_f32 v147, v178, v251
    v_fmac_f32 v154, v179, v250
    v_fmac_f32 v155, v179, v251
    v_lshlrev_b32 v250, 16, v82
    v_and_b32 v251, 0xffff0000, v82
    v_fmac_f32 v132, v176, v250
    v_fmac_f32 v133, v176, v251
    v_fmac_f32 v140, v177, v250
    v_fmac_f32 v141, v177, v251
    v_fmac_f32 v148, v178, v250
    v_fmac_f32 v149, v178, v251
    v_fmac_f32 v156, v179, v250
    v_fmac_f32 v157, v179, v251
    v_lshlrev_b32 v250, 16, v83
    v_and_b32 v251, 0xffff0000, v83
    v_fmac_f32 v134, v176, v250
    v_fmac_f32 v135, v176, v251
    v_fmac_f32 v142, v177, v250
    v_fmac_f32 v143, v177, v251
    v_fmac_f32 v150, v178, v250
    v_fmac_f32 v151, v178, v251
    v_fmac_f32 v158, v179, v250
    v_fmac_f32 v159, v179, v251
    s_waitcnt vmcnt(10)
    v_lshlrev_b32 v250, 16, v84
    v_and_b32 v251, 0xffff0000, v84
    v_fmac_f32 v128, v180, v250
    v_fmac_f32 v129, v180, v251
    v_fmac_f32 v136, v181, v250
    v_fmac_f32 v137, v181, v251
    v_fmac_f32 v144, v182, v250
    v_fmac_f32 v145, v182, v251
    v_fmac_f32 v152, v183, v250
    v_fmac_f32 v153, v183, v251
    v_lshlrev_b32 v250, 16, v85
    v_and_b32 v251, 0xffff0000, v85
    v_fmac_f32 v130, v180, v250
    v_fmac_f32 v131, v180, v251
    v_fmac_f32 v138, v181, v250
    v_fmac_f32 v139, v181, v251
    v_fmac_f32 v146, v182, v250
    v_fmac_f32 v147, v182, v251
    v_fmac_f32 v154, v183, v250
    v_fmac_f32 v155, v183, v251
    v_lshlrev_b32 v250, 16, v86
    v_and_b32 v251, 0xffff0000, v86
    v_fmac_f32 v132, v180, v250
    v_fmac_f32 v133, v180, v251
    v_fmac_f32 v140, v181, v250
    v_fmac_f32 v141, v181, v251
    v_fmac_f32 v148, v182, v250
    v_fmac_f32 v149, v182, v251
    v_fmac_f32 v156, v183, v250
    v_fmac_f32 v157, v183, v251
    v_lshlrev_b32 v250, 16, v87
    v_and_b32 v251, 0xffff0000, v87
    v_fmac_f32 v134, v180, v250
    v_fmac_f32 v135, v180, v251
    v_fmac_f32 v142, v181, v250
    v_fmac_f32 v143, v181, v251
    v_fmac_f32 v150, v182, v250
    v_fmac_f32 v151, v182, v251
    v_fmac_f32 v158, v183, v250
    v_fmac_f32 v159, v183, v251
    s_waitcnt vmcnt(9)
    v_lshlrev_b32 v250, 16, v88
    v_and_b32 v251, 0xffff0000, v88
    v_fmac_f32 v128, v184, v250
    v_fmac_f32 v129, v184, v251
    v_fmac_f32 v136, v185, v250
    v_fmac_f32 v137, v185, v251
    v_fmac_f32 v144, v186, v250
    v_fmac_f32 v145, v186, v251
    v_fmac_f32 v152, v187, v250
    v_fmac_f32 v153, v187, v251
    v_lshlrev_b32 v250, 16, v89
    v_and_b32 v251, 0xffff0000, v89
    v_fmac_f32 v130, v184, v250
    v_fmac_f32 v131, v184, v251
    v_fmac_f32 v138, v185, v250
    v_fmac_f32 v139, v185, v251
    v_fmac_f32 v146, v186, v250
    v_fmac_f32 v147, v186, v251
    v_fmac_f32 v154, v187, v250
    v_fmac_f32 v155, v187, v251
    v_lshlrev_b32 v250, 16, v90
    v_and_b32 v251, 0xffff0000, v90
    v_fmac_f32 v132, v184, v250
    v_fmac_f32 v133, v184, v251
    v_fmac_f32 v140, v185, v250
    v_fmac_f32 v141, v185, v251
    v_fmac_f32 v148, v186, v250
    v_fmac_f32 v149, v186, v251
    v_fmac_f32 v156, v187, v250
    v_fmac_f32 v157, v187, v251
    v_lshlrev_b32 v250, 16, v91
    v_and_b32 v251, 0xffff0000, v91
    v_fmac_f32 v134, v184, v250
    v_fmac_f32 v135, v184, v251
    v_fmac_f32 v142, v185, v250
    v_fmac_f32 v143, v185, v251
    v_fmac_f32 v150, v186, v250
    v_fmac_f32 v151, v186, v251
    v_fmac_f32 v158, v187, v250
    v_fmac_f32 v159, v187, v251
    s_waitcnt vmcnt(8)
    v_lshlrev_b32 v250, 16, v92
    v_and_b32 v251, 0xffff0000, v92
    v_fmac_f32 v128, v188, v250
    v_fmac_f32 v129, v188, v251
    v_fmac_f32 v136, v189, v250
    v_fmac_f32 v137, v189, v251
    v_fmac_f32 v144, v190, v250
    v_fmac_f32 v145, v190, v251
    v_fmac_f32 v152, v191, v250
    v_fmac_f32 v153, v191, v251
    v_lshlrev_b32 v250, 16, v93
    v_and_b32 v251, 0xffff0000, v93
    v_fmac_f32 v130, v188, v250
    v_fmac_f32 v131, v188, v251
    v_fmac_f32 v138, v189, v250
    v_fmac_f32 v139, v189, v251
    v_fmac_f32 v146, v190, v250
    v_fmac_f32 v147, v190, v251
    v_fmac_f32 v154, v191, v250
    v_fmac_f32 v155, v191, v251
    v_lshlrev_b32 v250, 16, v94
    v_and_b32 v251, 0xffff0000, v94
    v_fmac_f32 v132, v188, v250
    v_fmac_f32 v133, v188, v251
    v_fmac_f32 v140, v189, v250
    v_fmac_f32 v141, v189, v251
    v_fmac_f32 v148, v190, v250
    v_fmac_f32 v149, v190, v251
    v_fmac_f32 v156, v191, v250
    v_fmac_f32 v157, v191, v251
    v_lshlrev_b32 v250, 16, v95
    v_and_b32 v251, 0xffff0000, v95
    v_fmac_f32 v134, v188, v250
    v_fmac_f32 v135, v188, v251
    v_fmac_f32 v142, v189, v250
    v_fmac_f32 v143, v189, v251
    v_fmac_f32 v150, v190, v250
    v_fmac_f32 v151, v190, v251
    v_fmac_f32 v158, v191, v250
    v_fmac_f32 v159, v191, v251
    s_waitcnt vmcnt(7)
    v_lshlrev_b32 v250, 16, v96
    v_and_b32 v251, 0xffff0000, v96
    v_fmac_f32 v128, v192, v250
    v_fmac_f32 v129, v192, v251
    v_fmac_f32 v136, v193, v250
    v_fmac_f32 v137, v193, v251
    v_fmac_f32 v144, v194, v250
    v_fmac_f32 v145, v194, v251
    v_fmac_f32 v152, v195, v250
    v_fmac_f32 v153, v195, v251
    v_lshlrev_b32 v250, 16, v97
    v_and_b32 v251, 0xffff0000, v97
    v_fmac_f32 v130, v192, v250
    v_fmac_f32 v131, v192, v251
    v_fmac_f32 v138, v193, v250
    v_fmac_f32 v139, v193, v251
    v_fmac_f32 v146, v194, v250
    v_fmac_f32 v147, v194, v251
    v_fmac_f32 v154, v195, v250
    v_fmac_f32 v155, v195, v251
    v_lshlrev_b32 v250, 16, v98
    v_and_b32 v251, 0xffff0000, v98
    v_fmac_f32 v132, v192, v250
    v_fmac_f32 v133, v192, v251
    v_fmac_f32 v140, v193, v250
    v_fmac_f32 v141, v193, v251
    v_fmac_f32 v148, v194, v250
    v_fmac_f32 v149, v194, v251
    v_fmac_f32 v156, v195, v250
    v_fmac_f32 v157, v195, v251
    v_lshlrev_b32 v250, 16, v99
    v_and_b32 v251, 0xffff0000, v99
    v_fmac_f32 v134, v192, v250
    v_fmac_f32 v135, v192, v251
    v_fmac_f32 v142, v193, v250
    v_fmac_f32 v143, v193, v251
    v_fmac_f32 v150, v194, v250
    v_fmac_f32 v151, v194, v251
    v_fmac_f32 v158, v195, v250
    v_fmac_f32 v159, v195, v251
    s_waitcnt vmcnt(6)
    v_lshlrev_b32 v250, 16, v100
    v_and_b32 v251, 0xffff0000, v100
    v_fmac_f32 v128, v196, v250
    v_fmac_f32 v129, v196, v251
    v_fmac_f32 v136, v197, v250
    v_fmac_f32 v137, v197, v251
    v_fmac_f32 v144, v198, v250
    v_fmac_f32 v145, v198, v251
    v_fmac_f32 v152, v199, v250
    v_fmac_f32 v153, v199, v251
    v_lshlrev_b32 v250, 16, v101
    v_and_b32 v251, 0xffff0000, v101
    v_fmac_f32 v130, v196, v250
    v_fmac_f32 v131, v196, v251
    v_fmac_f32 v138, v197, v250
    v_fmac_f32 v139, v197, v251
    v_fmac_f32 v146, v198, v250
    v_fmac_f32 v147, v198, v251
    v_fmac_f32 v154, v199, v250
    v_fmac_f32 v155, v199, v251
    v_lshlrev_b32 v250, 16, v102
    v_and_b32 v251, 0xffff0000, v102
    v_fmac_f32 v132, v196, v250
    v_fmac_f32 v133, v196, v251
    v_fmac_f32 v140, v197, v250
    v_fmac_f32 v141, v197, v251
    v_fmac_f32 v148, v198, v250
    v_fmac_f32 v149, v198, v251
    v_fmac_f32 v156, v199, v250
    v_fmac_f32 v157, v199, v251
    v_lshlrev_b32 v250, 16, v103
    v_and_b32 v251, 0xffff0000, v103
    v_fmac_f32 v134, v196, v250
    v_fmac_f32 v135, v196, v251
    v_fmac_f32 v142, v197, v250
    v_fmac_f32 v143, v197, v251
    v_fmac_f32 v150, v198, v250
    v_fmac_f32 v151, v198, v251
    v_fmac_f32 v158, v199, v250
    v_fmac_f32 v159, v199, v251
    s_waitcnt vmcnt(5)
    v_lshlrev_b32 v250, 16, v104
    v_and_b32 v251, 0xffff0000, v104
    v_fmac_f32 v128, v200, v250
    v_fmac_f32 v129, v200, v251
    v_fmac_f32 v136, v201, v250
    v_fmac_f32 v137, v201, v251
    v_fmac_f32 v144, v202, v250
    v_fmac_f32 v145, v202, v251
    v_fmac_f32 v152, v203, v250
    v_fmac_f32 v153, v203, v251
    v_lshlrev_b32 v250, 16, v105
    v_and_b32 v251, 0xffff0000, v105
    v_fmac_f32 v130, v200, v250
    v_fmac_f32 v131, v200, v251
    v_fmac_f32 v138, v201, v250
    v_fmac_f32 v139, v201, v251
    v_fmac_f32 v146, v202, v250
    v_fmac_f32 v147, v202, v251
    v_fmac_f32 v154, v203, v250
    v_fmac_f32 v155, v203, v251
    v_lshlrev_b32 v250, 16, v106
    v_and_b32 v251, 0xffff0000, v106
    v_fmac_f32 v132, v200, v250
    v_fmac_f32 v133, v200, v251
    v_fmac_f32 v140, v201, v250
    v_fmac_f32 v141, v201, v251
    v_fmac_f32 v148, v202, v250
    v_fmac_f32 v149, v202, v251
    v_fmac_f32 v156, v203, v250
    v_fmac_f32 v157, v203, v251
    v_lshlrev_b32 v250, 16, v107
    v_and_b32 v251, 0xffff0000, v107
    v_fmac_f32 v134, v200, v250
    v_fmac_f32 v135, v200, v251
    v_fmac_f32 v142, v201, v250
    v_fmac_f32 v143, v201, v251
    v_fmac_f32 v150, v202, v250
    v_fmac_f32 v151, v202, v251
    v_fmac_f32 v158, v203, v250
    v_fmac_f32 v159, v203, v251
    s_waitcnt vmcnt(4)
    v_lshlrev_b32 v250, 16, v108
    v_and_b32 v251, 0xffff0000, v108
    v_fmac_f32 v128, v204, v250
    v_fmac_f32 v129, v204, v251
    v_fmac_f32 v136, v205, v250
    v_fmac_f32 v137, v205, v251
    v_fmac_f32 v144, v206, v250
    v_fmac_f32 v145, v206, v251
    v_fmac_f32 v152, v207, v250
    v_fmac_f32 v153, v207, v251
    v_lshlrev_b32 v250, 16, v109
    v_and_b32 v251, 0xffff0000, v109
    v_fmac_f32 v130, v204, v250
    v_fmac_f32 v131, v204, v251
    v_fmac_f32 v138, v205, v250
    v_fmac_f32 v139, v205, v251
    v_fmac_f32 v146, v206, v250
    v_fmac_f32 v147, v206, v251
    v_fmac_f32 v154, v207, v250
    v_fmac_f32 v155, v207, v251
    v_lshlrev_b32 v250, 16, v110
    v_and_b32 v251, 0xffff0000, v110
    v_fmac_f32 v132, v204, v250
    v_fmac_f32 v133, v204, v251
    v_fmac_f32 v140, v205, v250
    v_fmac_f32 v141, v205, v251
    v_fmac_f32 v148, v206, v250
    v_fmac_f32 v149, v206, v251
    v_fmac_f32 v156, v207, v250
    v_fmac_f32 v157, v207, v251
    v_lshlrev_b32 v250, 16, v111
    v_and_b32 v251, 0xffff0000, v111
    v_fmac_f32 v134, v204, v250
    v_fmac_f32 v135, v204, v251
    v_fmac_f32 v142, v205, v250
    v_fmac_f32 v143, v205, v251
    v_fmac_f32 v150, v206, v250
    v_fmac_f32 v151, v206, v251
    v_fmac_f32 v158, v207, v250
    v_fmac_f32 v159, v207, v251
    s_waitcnt vmcnt(3)
    v_lshlrev_b32 v250, 16, v112
    v_and_b32 v251, 0xffff0000, v112
    v_fmac_f32 v128, v208, v250
    v_fmac_f32 v129, v208, v251
    v_fmac_f32 v136, v209, v250
    v_fmac_f32 v137, v209, v251
    v_fmac_f32 v144, v210, v250
    v_fmac_f32 v145, v210, v251
    v_fmac_f32 v152, v211, v250
    v_fmac_f32 v153, v211, v251
    v_lshlrev_b32 v250, 16, v113
    v_and_b32 v251, 0xffff0000, v113
    v_fmac_f32 v130, v208, v250
    v_fmac_f32 v131, v208, v251
    v_fmac_f32 v138, v209, v250
    v_fmac_f32 v139, v209, v251
    v_fmac_f32 v146, v210, v250
    v_fmac_f32 v147, v210, v251
    v_fmac_f32 v154, v211, v250
    v_fmac_f32 v155, v211, v251
    v_lshlrev_b32 v250, 16, v114
    v_and_b32 v251, 0xffff0000, v114
    v_fmac_f32 v132, v208, v250
    v_fmac_f32 v133, v208, v251
    v_fmac_f32 v140, v209, v250
    v_fmac_f32 v141, v209, v251
    v_fmac_f32 v148, v210, v250
    v_fmac_f32 v149, v210, v251
    v_fmac_f32 v156, v211, v250
    v_fmac_f32 v157, v211, v251
    v_lshlrev_b32 v250, 16, v115
    v_and_b32 v251, 0xffff0000, v115
    v_fmac_f32 v134, v208, v250
    v_fmac_f32 v135, v208, v251
    v_fmac_f32 v142, v209, v250
    v_fmac_f32 v143, v209, v251
    v_fmac_f32 v150, v210, v250
    v_fmac_f32 v151, v210, v251
    v_fmac_f32 v158, v211, v250
    v_fmac_f32 v159, v211, v251
    s_waitcnt vmcnt(2)
    v_lshlrev_b32 v250, 16, v116
    v_and_b32 v251, 0xffff0000, v116
    v_fmac_f32 v128, v212, v250
    v_fmac_f32 v129, v212, v251
    v_fmac_f32 v136, v213, v250
    v_fmac_f32 v137, v213, v251
    v_fmac_f32 v144, v214, v250
    v_fmac_f32 v145, v214, v251
    v_fmac_f32 v152, v215, v250
    v_fmac_f32 v153, v215, v251
    v_lshlrev_b32 v250, 16, v117
    v_and_b32 v251, 0xffff0000, v117
    v_fmac_f32 v130, v212, v250
    v_fmac_f32 v131, v212, v251
    v_fmac_f32 v138, v213, v250
    v_fmac_f32 v139, v213, v251
    v_fmac_f32 v146, v214, v250
    v_fmac_f32 v147, v214, v251
    v_fmac_f32 v154, v215, v250
    v_fmac_f32 v155, v215, v251
    v_lshlrev_b32 v250, 16, v118
    v_and_b32 v251, 0xffff0000, v118
    v_fmac_f32 v132, v212, v250
    v_fmac_f32 v133, v212, v251
    v_fmac_f32 v140, v213, v250
    v_fmac_f32 v141, v213, v251
    v_fmac_f32 v148, v214, v250
    v_fmac_f32 v149, v214, v251
    v_fmac_f32 v156, v215, v250
    v_fmac_f32 v157, v215, v251
    v_lshlrev_b32 v250, 16, v119
    v_and_b32 v251, 0xffff0000, v119
    v_fmac_f32 v134, v212, v250
    v_fmac_f32 v135, v212, v251
    v_fmac_f32 v142, v213, v250
    v_fmac_f32 v143, v213, v251
    v_fmac_f32 v150, v214, v250
    v_fmac_f32 v151, v214, v251
    v_fmac_f32 v158, v215, v250
    v_fmac_f32 v159, v215, v251
    s_waitcnt vmcnt(1)
    v_lshlrev_b32 v250, 16, v120
    v_and_b32 v251, 0xffff0000, v120
    v_fmac_f32 v128, v216, v250
    v_fmac_f32 v129, v216, v251
    v_fmac_f32 v136, v217, v250
    v_fmac_f32 v137, v217, v251
    v_fmac_f32 v144, v218, v250
    v_fmac_f32 v145, v218, v251
    v_fmac_f32 v152, v219, v250
    v_fmac_f32 v153, v219, v251
    v_lshlrev_b32 v250, 16, v121
    v_and_b32 v251, 0xffff0000, v121
    v_fmac_f32 v130, v216, v250
    v_fmac_f32 v131, v216, v251
    v_fmac_f32 v138, v217, v250
    v_fmac_f32 v139, v217, v251
    v_fmac_f32 v146, v218, v250
    v_fmac_f32 v147, v218, v251
    v_fmac_f32 v154, v219, v250
    v_fmac_f32 v155, v219, v251
    v_lshlrev_b32 v250, 16, v122
    v_and_b32 v251, 0xffff0000, v122
    v_fmac_f32 v132, v216, v250
    v_fmac_f32 v133, v216, v251
    v_fmac_f32 v140, v217, v250
    v_fmac_f32 v141, v217, v251
    v_fmac_f32 v148, v218, v250
    v_fmac_f32 v149, v218, v251
    v_fmac_f32 v156, v219, v250
    v_fmac_f32 v157, v219, v251
    v_lshlrev_b32 v250, 16, v123
    v_and_b32 v251, 0xffff0000, v123
    v_fmac_f32 v134, v216, v250
    v_fmac_f32 v135, v216, v251
    v_fmac_f32 v142, v217, v250
    v_fmac_f32 v143, v217, v251
    v_fmac_f32 v150, v218, v250
    v_fmac_f32 v151, v218, v251
    v_fmac_f32 v158, v219, v250
    v_fmac_f32 v159, v219, v251
    s_waitcnt vmcnt(0)
    v_lshlrev_b32 v250, 16, v124
    v_and_b32 v251, 0xffff0000, v124
    v_fmac_f32 v128, v220, v250
    v_fmac_f32 v129, v220, v251
    v_fmac_f32 v136, v221, v250
    v_fmac_f32 v137, v221, v251
    v_fmac_f32 v144, v222, v250
    v_fmac_f32 v145, v222, v251
    v_fmac_f32 v152, v223, v250
    v_fmac_f32 v153, v223, v251
    v_lshlrev_b32 v250, 16, v125
    v_and_b32 v251, 0xffff0000, v125
    v_fmac_f32 v130, v220, v250
    v_fmac_f32 v131, v220, v251
    v_fmac_f32 v138, v221, v250
    v_fmac_f32 v139, v221, v251
    v_fmac_f32 v146, v222, v250
    v_fmac_f32 v147, v222, v251
    v_fmac_f32 v154, v223, v250
    v_fmac_f32 v155, v223, v251
    v_lshlrev_b32 v250, 16, v126
    v_and_b32 v251, 0xffff0000, v126
    v_fmac_f32 v132, v220, v250
    v_fmac_f32 v133, v220, v251
    v_fmac_f32 v140, v221, v250
    v_fmac_f32 v141, v221, v251
    v_fmac_f32 v148, v222, v250
    v_fmac_f32 v149, v222, v251
    v_fmac_f32 v156, v223, v250
    v_fmac_f32 v157, v223, v251
    v_lshlrev_b32 v250, 16, v127
    v_and_b32 v251, 0xffff0000, v127
    v_fmac_f32 v134, v220, v250
    v_fmac_f32 v135, v220, v251
    v_fmac_f32 v142, v221, v250
    v_fmac_f32 v143, v221, v251
    v_fmac_f32 v150, v222, v250
    v_fmac_f32 v151, v222, v251
    v_fmac_f32 v158, v223, v250
    v_fmac_f32 v159, v223, v251
    v_mul_u32_u24 v3, 9216, v1
    v_lshl_add_u32 v3, v2, 5, v3
    ds_write_b128 v3, v[128:131] offset:4096
    ds_write_b128 v3, v[132:135] offset:4112
    ds_write_b128 v3, v[136:139] offset:6400
    ds_write_b128 v3, v[140:143] offset:6416
    ds_write_b128 v3, v[144:147] offset:8704
    ds_write_b128 v3, v[148:151] offset:8720
    ds_write_b128 v3, v[152:155] offset:11008
    ds_write_b128 v3, v[156:159] offset:11024
    s_waitcnt lgkmcnt(0)
    s_barrier
    v_mul_u32_u24 v3, 2304, v1
    v_lshl_add_u32 v3, v2, 5, v3
    ds_read_b128 v[128:131], v3 offset:4096
    ds_read_b128 v[132:135], v3 offset:4112
    ds_read_b128 v[136:139], v3 offset:13312
    ds_read_b128 v[140:143], v3 offset:13328
    ds_read_b128 v[144:147], v3 offset:22528
    ds_read_b128 v[148:151], v3 offset:22544
    ds_read_b128 v[152:155], v3 offset:31744
    ds_read_b128 v[156:159], v3 offset:31760
    s_waitcnt lgkmcnt(0)
    v_add_f32 v128, v128, v136
    v_add_f32 v129, v129, v137
    v_add_f32 v130, v130, v138
    v_add_f32 v131, v131, v139
    v_add_f32 v132, v132, v140
    v_add_f32 v133, v133, v141
    v_add_f32 v134, v134, v142
    v_add_f32 v135, v135, v143
    v_add_f32 v128, v128, v144
    v_add_f32 v129, v129, v145
    v_add_f32 v130, v130, v146
    v_add_f32 v131, v131, v147
    v_add_f32 v132, v132, v148
    v_add_f32 v133, v133, v149
    v_add_f32 v134, v134, v150
    v_add_f32 v135, v135, v151
    v_add_f32 v128, v128, v152
    v_add_f32 v129, v129, v153
    v_add_f32 v130, v130, v154
    v_add_f32 v131, v131, v155
    v_add_f32 v132, v132, v156
    v_add_f32 v133, v133, v157
    v_add_f32 v134, v134, v158
    v_add_f32 v135, v135, v159
    s_mul_i32 s29, s2, 9216
    s_add_u32 s29, s29, 1179648
    s_add_u32 s30, s8, s29
    s_addc_u32 s31, s9, 0
    global_store_dwordx4 v3, v[128:131], s[30:31]
    global_store_dwordx4 v3, v[132:135], s[30:31] offset:16
k4_end:
    s_endpgm
.globl k4b_red_kernel
.p2align 8
.type k4b_red_kernel,@function
k4b_red_kernel:
    s_load_dwordx2 s[8:9], s[0:1], 104
    s_cmp_ge_u32 s2, 4
    s_cbranch_scc1 k4b_end
    s_mul_i32 s20, s2, 576
    v_add_u32 v1, s20, v0
    v_lshlrev_b32 v3, 2, v1
    s_waitcnt lgkmcnt(0)
    s_add_u32 s30, s8, 1179648
    s_addc_u32 s31, s9, 0
    global_load_dword v16, v3, s[30:31]
    s_add_u32 s30, s30, 9216
    s_addc_u32 s31, s31, 0
    global_load_dword v17, v3, s[30:31]
    s_add_u32 s30, s30, 9216
    s_addc_u32 s31, s31, 0
    global_load_dword v18, v3, s[30:31]
    s_add_u32 s30, s30, 9216
    s_addc_u32 s31, s31, 0
    global_load_dword v19, v3, s[30:31]
    s_add_u32 s30, s30, 9216
    s_addc_u32 s31, s31, 0
    global_load_dword v20, v3, s[30:31]
    s_add_u32 s30, s30, 9216
    s_addc_u32 s31, s31, 0
    global_load_dword v21, v3, s[30:31]
    s_add_u32 s30, s30, 9216
    s_addc_u32 s31, s31, 0
    global_load_dword v22, v3, s[30:31]
    s_add_u32 s30, s30, 9216
    s_addc_u32 s31, s31, 0
    global_load_dword v23, v3, s[30:31]
    s_add_u32 s30, s30, 9216
    s_addc_u32 s31, s31, 0
    global_load_dword v24, v3, s[30:31]
    s_add_u32 s30, s30, 9216
    s_addc_u32 s31, s31, 0
    global_load_dword v25, v3, s[30:31]
    s_add_u32 s30, s30, 9216
    s_addc_u32 s31, s31, 0
    global_load_dword v26, v3, s[30:31]
    s_add_u32 s30, s30, 9216
    s_addc_u32 s31, s31, 0
    global_load_dword v27, v3, s[30:31]
    s_add_u32 s30, s30, 9216
    s_addc_u32 s31, s31, 0
    global_load_dword v28, v3, s[30:31]
    s_add_u32 s30, s30, 9216
    s_addc_u32 s31, s31, 0
    global_load_dword v29, v3, s[30:31]
    s_add_u32 s30, s30, 9216
    s_addc_u32 s31, s31, 0
    global_load_dword v30, v3, s[30:31]
    s_add_u32 s30, s30, 9216
    s_addc_u32 s31, s31, 0
    global_load_dword v31, v3, s[30:31]
    s_add_u32 s30, s30, 9216
    s_addc_u32 s31, s31, 0
    global_load_dword v32, v3, s[30:31]
    s_add_u32 s30, s30, 9216
    s_addc_u32 s31, s31, 0
    global_load_dword v33, v3, s[30:31]
    s_add_u32 s30, s30, 9216
    s_addc_u32 s31, s31, 0
    global_load_dword v34, v3, s[30:31]
    s_add_u32 s30, s30, 9216
    s_addc_u32 s31, s31, 0
    global_load_dword v35, v3, s[30:31]
    s_add_u32 s30, s30, 9216
    s_addc_u32 s31, s31, 0
    global_load_dword v36, v3, s[30:31]
    s_add_u32 s30, s30, 9216
    s_addc_u32 s31, s31, 0
    global_load_dword v37, v3, s[30:31]
    s_add_u32 s30, s30, 9216
    s_addc_u32 s31, s31, 0
    global_load_dword v38, v3, s[30:31]
    s_add_u32 s30, s30, 9216
    s_addc_u32 s31, s31, 0
    global_load_dword v39, v3, s[30:31]
    s_add_u32 s30, s30, 9216
    s_addc_u32 s31, s31, 0
    global_load_dword v40, v3, s[30:31]
    s_add_u32 s30, s30, 9216
    s_addc_u32 s31, s31, 0
    global_load_dword v41, v3, s[30:31]
    s_add_u32 s30, s30, 9216
    s_addc_u32 s31, s31, 0
    global_load_dword v42, v3, s[30:31]
    s_add_u32 s30, s30, 9216
    s_addc_u32 s31, s31, 0
    global_load_dword v43, v3, s[30:31]
    s_add_u32 s30, s30, 9216
    s_addc_u32 s31, s31, 0
    global_load_dword v44, v3, s[30:31]
    s_add_u32 s30, s30, 9216
    s_addc_u32 s31, s31, 0
    global_load_dword v45, v3, s[30:31]
    s_add_u32 s30, s30, 9216
    s_addc_u32 s31, s31, 0
    global_load_dword v46, v3, s[30:31]
    s_add_u32 s30, s30, 9216
    s_addc_u32 s31, s31, 0
    global_load_dword v47, v3, s[30:31]
    s_add_u32 s30, s30, 9216
    s_addc_u32 s31, s31, 0
    global_load_dword v48, v3, s[30:31]
    s_add_u32 s30, s30, 9216
    s_addc_u32 s31, s31, 0
    global_load_dword v49, v3, s[30:31]
    s_add_u32 s30, s30, 9216
    s_addc_u32 s31, s31, 0
    global_load_dword v50, v3, s[30:31]
    s_add_u32 s30, s30, 9216
    s_addc_u32 s31, s31, 0
    global_load_dword v51, v3, s[30:31]
    s_add_u32 s30, s30, 9216
    s_addc_u32 s31, s31, 0
    global_load_dword v52, v3, s[30:31]
    s_add_u32 s30, s30, 9216
    s_addc_u32 s31, s31, 0
    global_load_dword v53, v3, s[30:31]
    s_add_u32 s30, s30, 9216
    s_addc_u32 s31, s31, 0
    global_load_dword v54, v3, s[30:31]
    s_add_u32 s30, s30, 9216
    s_addc_u32 s31, s31, 0
    global_load_dword v55, v3, s[30:31]
    s_add_u32 s30, s30, 9216
    s_addc_u32 s31, s31, 0
    global_load_dword v56, v3, s[30:31]
    s_add_u32 s30, s30, 9216
    s_addc_u32 s31, s31, 0
    global_load_dword v57, v3, s[30:31]
    s_add_u32 s30, s30, 9216
    s_addc_u32 s31, s31, 0
    global_load_dword v58, v3, s[30:31]
    s_add_u32 s30, s30, 9216
    s_addc_u32 s31, s31, 0
    global_load_dword v59, v3, s[30:31]
    s_add_u32 s30, s30, 9216
    s_addc_u32 s31, s31, 0
    global_load_dword v60, v3, s[30:31]
    s_add_u32 s30, s30, 9216
    s_addc_u32 s31, s31, 0
    global_load_dword v61, v3, s[30:31]
    s_add_u32 s30, s30, 9216
    s_addc_u32 s31, s31, 0
    global_load_dword v62, v3, s[30:31]
    s_add_u32 s30, s30, 9216
    s_addc_u32 s31, s31, 0
    global_load_dword v63, v3, s[30:31]
    s_add_u32 s30, s30, 9216
    s_addc_u32 s31, s31, 0
    global_load_dword v64, v3, s[30:31]
    s_add_u32 s30, s30, 9216
    s_addc_u32 s31, s31, 0
    global_load_dword v65, v3, s[30:31]
    s_add_u32 s30, s30, 9216
    s_addc_u32 s31, s31, 0
    global_load_dword v66, v3, s[30:31]
    s_add_u32 s30, s30, 9216
    s_addc_u32 s31, s31, 0
    global_load_dword v67, v3, s[30:31]
    s_add_u32 s30, s30, 9216
    s_addc_u32 s31, s31, 0
    global_load_dword v68, v3, s[30:31]
    s_add_u32 s30, s30, 9216
    s_addc_u32 s31, s31, 0
    global_load_dword v69, v3, s[30:31]
    s_add_u32 s30, s30, 9216
    s_addc_u32 s31, s31, 0
    global_load_dword v70, v3, s[30:31]
    s_add_u32 s30, s30, 9216
    s_addc_u32 s31, s31, 0
    global_load_dword v71, v3, s[30:31]
    s_add_u32 s30, s30, 9216
    s_addc_u32 s31, s31, 0
    global_load_dword v72, v3, s[30:31]
    s_add_u32 s30, s30, 9216
    s_addc_u32 s31, s31, 0
    global_load_dword v73, v3, s[30:31]
    s_add_u32 s30, s30, 9216
    s_addc_u32 s31, s31, 0
    global_load_dword v74, v3, s[30:31]
    s_add_u32 s30, s30, 9216
    s_addc_u32 s31, s31, 0
    global_load_dword v75, v3, s[30:31]
    s_add_u32 s30, s30, 9216
    s_addc_u32 s31, s31, 0
    global_load_dword v76, v3, s[30:31]
    s_add_u32 s30, s30, 9216
    s_addc_u32 s31, s31, 0
    global_load_dword v77, v3, s[30:31]
    s_add_u32 s30, s30, 9216
    s_addc_u32 s31, s31, 0
    global_load_dword v78, v3, s[30:31]
    s_add_u32 s30, s30, 9216
    s_addc_u32 s31, s31, 0
    global_load_dword v79, v3, s[30:31]
    s_add_u32 s30, s30, 9216
    s_addc_u32 s31, s31, 0
    s_waitcnt vmcnt(0)
    v_add_f32 v16, v16, v17
    v_add_f32 v16, v16, v18
    v_add_f32 v16, v16, v19
    v_add_f32 v16, v16, v20
    v_add_f32 v16, v16, v21
    v_add_f32 v16, v16, v22
    v_add_f32 v16, v16, v23
    v_add_f32 v16, v16, v24
    v_add_f32 v16, v16, v25
    v_add_f32 v16, v16, v26
    v_add_f32 v16, v16, v27
    v_add_f32 v16, v16, v28
    v_add_f32 v16, v16, v29
    v_add_f32 v16, v16, v30
    v_add_f32 v16, v16, v31
    v_add_f32 v16, v16, v32
    v_add_f32 v16, v16, v33
    v_add_f32 v16, v16, v34
    v_add_f32 v16, v16, v35
    v_add_f32 v16, v16, v36
    v_add_f32 v16, v16, v37
    v_add_f32 v16, v16, v38
    v_add_f32 v16, v16, v39
    v_add_f32 v16, v16, v40
    v_add_f32 v16, v16, v41
    v_add_f32 v16, v16, v42
    v_add_f32 v16, v16, v43
    v_add_f32 v16, v16, v44
    v_add_f32 v16, v16, v45
    v_add_f32 v16, v16, v46
    v_add_f32 v16, v16, v47
    v_add_f32 v16, v16, v48
    v_add_f32 v16, v16, v49
    v_add_f32 v16, v16, v50
    v_add_f32 v16, v16, v51
    v_add_f32 v16, v16, v52
    v_add_f32 v16, v16, v53
    v_add_f32 v16, v16, v54
    v_add_f32 v16, v16, v55
    v_add_f32 v16, v16, v56
    v_add_f32 v16, v16, v57
    v_add_f32 v16, v16, v58
    v_add_f32 v16, v16, v59
    v_add_f32 v16, v16, v60
    v_add_f32 v16, v16, v61
    v_add_f32 v16, v16, v62
    v_add_f32 v16, v16, v63
    v_add_f32 v16, v16, v64
    v_add_f32 v16, v16, v65
    v_add_f32 v16, v16, v66
    v_add_f32 v16, v16, v67
    v_add_f32 v16, v16, v68
    v_add_f32 v16, v16, v69
    v_add_f32 v16, v16, v70
    v_add_f32 v16, v16, v71
    v_add_f32 v16, v16, v72
    v_add_f32 v16, v16, v73
    v_add_f32 v16, v16, v74
    v_add_f32 v16, v16, v75
    v_add_f32 v16, v16, v76
    v_add_f32 v16, v16, v77
    v_add_f32 v16, v16, v78
    v_add_f32 v16, v16, v79
    s_add_u32 s30, s8, 1114112
    s_addc_u32 s31, s9, 0
    global_store_dword v3, v16, s[30:31]
k4b_end:
    s_endpgm
.globl k5_ffn_kernel
.p2align 8
.type k5_ffn_kernel,@function
k5_ffn_kernel:
    s_load_dwordx2 s[4:5], s[0:1], 0
    s_load_dwordx2 s[10:11], s[0:1], 48
    s_load_dwordx2 s[12:13], s[0:1], 56
    s_load_dwordx2 s[14:15], s[0:1], 64
    s_load_dwordx2 s[8:9], s[0:1], 104
    s_cmp_ge_u32 s2, 144
    s_cbranch_scc1 k5_end
    v_lshrrev_b32 v5, 6, v0
    v_and_b32 v6, 63, v0
    s_waitcnt lgkmcnt(0)
    v_mul_u32_u24 v1, 911, v0
    v_lshrrev_b32 v1, 16, v1
    v_mul_u32_u24 v2, 72, v1
    v_sub_u32 v2, v0, v2
    v_cmp_gt_u32 vcc, 256, v0
    s_and_saveexec_b64 s[34:35], vcc
    s_cbranch_execz k5_skip1
    v_mul_u32_u24 v7, 576, v5
    v_add_u32 v7, v7, v6
    v_lshlrev_b32 v3, 1, v7
    global_load_ushort v32, v3, s[4:5] offset:0
    global_load_ushort v33, v3, s[4:5] offset:128
    global_load_ushort v34, v3, s[4:5] offset:256
    global_load_ushort v35, v3, s[4:5] offset:384
    global_load_ushort v36, v3, s[4:5] offset:512
    global_load_ushort v37, v3, s[4:5] offset:640
    global_load_ushort v38, v3, s[4:5] offset:768
    global_load_ushort v39, v3, s[4:5] offset:896
    global_load_ushort v40, v3, s[4:5] offset:1024
    v_lshlrev_b32 v3, 2, v7
    s_add_u32 s30, s8, 1114112
    s_addc_u32 s31, s9, 0
    global_load_dword v44, v3, s[30:31] offset:0
    global_load_dword v45, v3, s[30:31] offset:256
    global_load_dword v46, v3, s[30:31] offset:512
    global_load_dword v47, v3, s[30:31] offset:768
    global_load_dword v48, v3, s[30:31] offset:1024
    global_load_dword v49, v3, s[30:31] offset:1280
    global_load_dword v50, v3, s[30:31] offset:1536
    global_load_dword v51, v3, s[30:31] offset:1792
    global_load_dword v52, v3, s[30:31] offset:2048
    v_mul_u32_u24 v7, 3456, v5
    v_add_u32 v7, v7, v6
    v_lshlrev_b32 v7, 2, v7
    s_add_u32 s30, s8, 4608
    s_addc_u32 s31, s9, 0
    global_load_dword v100, v7, s[30:31]
    s_add_u32 s30, s8, 4864
    s_addc_u32 s31, s9, 0
    global_load_dword v101, v7, s[30:31]
    s_add_u32 s30, s8, 5120
    s_addc_u32 s31, s9, 0
    global_load_dword v102, v7, s[30:31]
    s_add_u32 s30, s8, 5376
    s_addc_u32 s31, s9, 0
    global_load_dword v103, v7, s[30:31]
    s_add_u32 s30, s8, 5632
    s_addc_u32 s31, s9, 0
    global_load_dword v104, v7, s[30:31]
    s_add_u32 s30, s8, 5888
    s_addc_u32 s31, s9, 0
    global_load_dword v105, v7, s[30:31]
    s_add_u32 s30, s8, 6144
    s_addc_u32 s31, s9, 0
    global_load_dword v106, v7, s[30:31]
    s_add_u32 s30, s8, 6400
    s_addc_u32 s31, s9, 0
    global_load_dword v107, v7, s[30:31]
    s_add_u32 s30, s8, 6656
    s_addc_u32 s31, s9, 0
    global_load_dword v108, v7, s[30:31]
    s_add_u32 s30, s8, 59904
    s_addc_u32 s31, s9, 0
    global_load_dword v109, v7, s[30:31]
    s_add_u32 s30, s8, 60160
    s_addc_u32 s31, s9, 0
    global_load_dword v110, v7, s[30:31]
    s_add_u32 s30, s8, 60416
    s_addc_u32 s31, s9, 0
    global_load_dword v111, v7, s[30:31]
    s_add_u32 s30, s8, 60672
    s_addc_u32 s31, s9, 0
    global_load_dword v112, v7, s[30:31]
    s_add_u32 s30, s8, 60928
    s_addc_u32 s31, s9, 0
    global_load_dword v113, v7, s[30:31]
    s_add_u32 s30, s8, 61184
    s_addc_u32 s31, s9, 0
    global_load_dword v114, v7, s[30:31]
    s_add_u32 s30, s8, 61440
    s_addc_u32 s31, s9, 0
    global_load_dword v115, v7, s[30:31]
    s_add_u32 s30, s8, 61696
    s_addc_u32 s31, s9, 0
    global_load_dword v116, v7, s[30:31]
    s_add_u32 s30, s8, 61952
    s_addc_u32 s31, s9, 0
    global_load_dword v117, v7, s[30:31]
    s_add_u32 s30, s8, 115200
    s_addc_u32 s31, s9, 0
    global_load_dword v118, v7, s[30:31]
    s_add_u32 s30, s8, 115456
    s_addc_u32 s31, s9, 0
    global_load_dword v119, v7, s[30:31]
    s_add_u32 s30, s8, 115712
    s_addc_u32 s31, s9, 0
    global_load_dword v120, v7, s[30:31]
    s_add_u32 s30, s8, 115968
    s_addc_u32 s31, s9, 0
    global_load_dword v121, v7, s[30:31]
    s_add_u32 s30, s8, 116224
    s_addc_u32 s31, s9, 0
    global_load_dword v122, v7, s[30:31]
    s_add_u32 s30, s8, 116480
    s_addc_u32 s31, s9, 0
    global_load_dword v123, v7, s[30:31]
    s_add_u32 s30, s8, 116736
    s_addc_u32 s31, s9, 0
    global_load_dword v124, v7, s[30:31]
    s_add_u32 s30, s8, 116992
    s_addc_u32 s31, s9, 0
    global_load_dword v125, v7, s[30:31]
    s_add_u32 s30, s8, 117248
    s_addc_u32 s31, s9, 0
    global_load_dword v126, v7, s[30:31]
    s_add_u32 s30, s8, 170496
    s_addc_u32 s31, s9, 0
    global_load_dword v127, v7, s[30:31]
    s_add_u32 s30, s8, 170752
    s_addc_u32 s31, s9, 0
    global_load_dword v128, v7, s[30:31]
    s_add_u32 s30, s8, 171008
    s_addc_u32 s31, s9, 0
    global_load_dword v129, v7, s[30:31]
    s_add_u32 s30, s8, 171264
    s_addc_u32 s31, s9, 0
    global_load_dword v130, v7, s[30:31]
    s_add_u32 s30, s8, 171520
    s_addc_u32 s31, s9, 0
    global_load_dword v131, v7, s[30:31]
    s_add_u32 s30, s8, 171776
    s_addc_u32 s31, s9, 0
    global_load_dword v132, v7, s[30:31]
    s_add_u32 s30, s8, 172032
    s_addc_u32 s31, s9, 0
    global_load_dword v133, v7, s[30:31]
    s_add_u32 s30, s8, 172288
    s_addc_u32 s31, s9, 0
    global_load_dword v134, v7, s[30:31]
    s_add_u32 s30, s8, 172544
    s_addc_u32 s31, s9, 0
    global_load_dword v135, v7, s[30:31]
    s_add_u32 s30, s8, 6912
    s_addc_u32 s31, s9, 0
    global_load_dword v140, v7, s[30:31]
    s_add_u32 s30, s8, 7168
    s_addc_u32 s31, s9, 0
    global_load_dword v141, v7, s[30:31]
    s_add_u32 s30, s8, 7424
    s_addc_u32 s31, s9, 0
    global_load_dword v142, v7, s[30:31]
    s_add_u32 s30, s8, 7680
    s_addc_u32 s31, s9, 0
    global_load_dword v143, v7, s[30:31]
    s_add_u32 s30, s8, 7936
    s_addc_u32 s31, s9, 0
    global_load_dword v144, v7, s[30:31]
    s_add_u32 s30, s8, 8192
    s_addc_u32 s31, s9, 0
    global_load_dword v145, v7, s[30:31]
    s_add_u32 s30, s8, 8448
    s_addc_u32 s31, s9, 0
    global_load_dword v146, v7, s[30:31]
    s_add_u32 s30, s8, 8704
    s_addc_u32 s31, s9, 0
    global_load_dword v147, v7, s[30:31]
    s_add_u32 s30, s8, 8960
    s_addc_u32 s31, s9, 0
    global_load_dword v148, v7, s[30:31]
    s_add_u32 s30, s8, 62208
    s_addc_u32 s31, s9, 0
    global_load_dword v149, v7, s[30:31]
    s_add_u32 s30, s8, 62464
    s_addc_u32 s31, s9, 0
    global_load_dword v150, v7, s[30:31]
    s_add_u32 s30, s8, 62720
    s_addc_u32 s31, s9, 0
    global_load_dword v151, v7, s[30:31]
    s_add_u32 s30, s8, 62976
    s_addc_u32 s31, s9, 0
    global_load_dword v152, v7, s[30:31]
    s_add_u32 s30, s8, 63232
    s_addc_u32 s31, s9, 0
    global_load_dword v153, v7, s[30:31]
    s_add_u32 s30, s8, 63488
    s_addc_u32 s31, s9, 0
    global_load_dword v154, v7, s[30:31]
    s_add_u32 s30, s8, 63744
    s_addc_u32 s31, s9, 0
    global_load_dword v155, v7, s[30:31]
    s_add_u32 s30, s8, 64000
    s_addc_u32 s31, s9, 0
    global_load_dword v156, v7, s[30:31]
    s_add_u32 s30, s8, 64256
    s_addc_u32 s31, s9, 0
    global_load_dword v157, v7, s[30:31]
    s_add_u32 s30, s8, 117504
    s_addc_u32 s31, s9, 0
    global_load_dword v158, v7, s[30:31]
    s_add_u32 s30, s8, 117760
    s_addc_u32 s31, s9, 0
    global_load_dword v159, v7, s[30:31]
    s_add_u32 s30, s8, 118016
    s_addc_u32 s31, s9, 0
    global_load_dword v160, v7, s[30:31]
    s_add_u32 s30, s8, 118272
    s_addc_u32 s31, s9, 0
    global_load_dword v161, v7, s[30:31]
    s_add_u32 s30, s8, 118528
    s_addc_u32 s31, s9, 0
    global_load_dword v162, v7, s[30:31]
    s_add_u32 s30, s8, 118784
    s_addc_u32 s31, s9, 0
    global_load_dword v163, v7, s[30:31]
    s_add_u32 s30, s8, 119040
    s_addc_u32 s31, s9, 0
    global_load_dword v164, v7, s[30:31]
    s_add_u32 s30, s8, 119296
    s_addc_u32 s31, s9, 0
    global_load_dword v165, v7, s[30:31]
    s_add_u32 s30, s8, 119552
    s_addc_u32 s31, s9, 0
    global_load_dword v166, v7, s[30:31]
    s_add_u32 s30, s8, 172800
    s_addc_u32 s31, s9, 0
    global_load_dword v167, v7, s[30:31]
    s_add_u32 s30, s8, 173056
    s_addc_u32 s31, s9, 0
    global_load_dword v168, v7, s[30:31]
    s_add_u32 s30, s8, 173312
    s_addc_u32 s31, s9, 0
    global_load_dword v169, v7, s[30:31]
    s_add_u32 s30, s8, 173568
    s_addc_u32 s31, s9, 0
    global_load_dword v170, v7, s[30:31]
    s_add_u32 s30, s8, 173824
    s_addc_u32 s31, s9, 0
    global_load_dword v171, v7, s[30:31]
    s_add_u32 s30, s8, 174080
    s_addc_u32 s31, s9, 0
    global_load_dword v172, v7, s[30:31]
    s_add_u32 s30, s8, 174336
    s_addc_u32 s31, s9, 0
    global_load_dword v173, v7, s[30:31]
    s_add_u32 s30, s8, 174592
    s_addc_u32 s31, s9, 0
    global_load_dword v174, v7, s[30:31]
    s_add_u32 s30, s8, 174848
    s_addc_u32 s31, s9, 0
    global_load_dword v175, v7, s[30:31]
    s_add_u32 s30, s8, 9216
    s_addc_u32 s31, s9, 0
    global_load_dword v180, v7, s[30:31]
    s_add_u32 s30, s8, 9472
    s_addc_u32 s31, s9, 0
    global_load_dword v181, v7, s[30:31]
    s_add_u32 s30, s8, 9728
    s_addc_u32 s31, s9, 0
    global_load_dword v182, v7, s[30:31]
    s_add_u32 s30, s8, 9984
    s_addc_u32 s31, s9, 0
    global_load_dword v183, v7, s[30:31]
    s_add_u32 s30, s8, 10240
    s_addc_u32 s31, s9, 0
    global_load_dword v184, v7, s[30:31]
    s_add_u32 s30, s8, 10496
    s_addc_u32 s31, s9, 0
    global_load_dword v185, v7, s[30:31]
    s_add_u32 s30, s8, 10752
    s_addc_u32 s31, s9, 0
    global_load_dword v186, v7, s[30:31]
    s_add_u32 s30, s8, 11008
    s_addc_u32 s31, s9, 0
    global_load_dword v187, v7, s[30:31]
    s_add_u32 s30, s8, 11264
    s_addc_u32 s31, s9, 0
    global_load_dword v188, v7, s[30:31]
    s_add_u32 s30, s8, 64512
    s_addc_u32 s31, s9, 0
    global_load_dword v189, v7, s[30:31]
    s_add_u32 s30, s8, 64768
    s_addc_u32 s31, s9, 0
    global_load_dword v190, v7, s[30:31]
    s_add_u32 s30, s8, 65024
    s_addc_u32 s31, s9, 0
    global_load_dword v191, v7, s[30:31]
    s_add_u32 s30, s8, 65280
    s_addc_u32 s31, s9, 0
    global_load_dword v192, v7, s[30:31]
    s_add_u32 s30, s8, 65536
    s_addc_u32 s31, s9, 0
    global_load_dword v193, v7, s[30:31]
    s_add_u32 s30, s8, 65792
    s_addc_u32 s31, s9, 0
    global_load_dword v194, v7, s[30:31]
    s_add_u32 s30, s8, 66048
    s_addc_u32 s31, s9, 0
    global_load_dword v195, v7, s[30:31]
    s_add_u32 s30, s8, 66304
    s_addc_u32 s31, s9, 0
    global_load_dword v196, v7, s[30:31]
    s_add_u32 s30, s8, 66560
    s_addc_u32 s31, s9, 0
    global_load_dword v197, v7, s[30:31]
    s_add_u32 s30, s8, 119808
    s_addc_u32 s31, s9, 0
    global_load_dword v198, v7, s[30:31]
    s_add_u32 s30, s8, 120064
    s_addc_u32 s31, s9, 0
    global_load_dword v199, v7, s[30:31]
    s_add_u32 s30, s8, 120320
    s_addc_u32 s31, s9, 0
    global_load_dword v200, v7, s[30:31]
    s_add_u32 s30, s8, 120576
    s_addc_u32 s31, s9, 0
    global_load_dword v201, v7, s[30:31]
    s_add_u32 s30, s8, 120832
    s_addc_u32 s31, s9, 0
    global_load_dword v202, v7, s[30:31]
    s_add_u32 s30, s8, 121088
    s_addc_u32 s31, s9, 0
    global_load_dword v203, v7, s[30:31]
    s_add_u32 s30, s8, 121344
    s_addc_u32 s31, s9, 0
    global_load_dword v204, v7, s[30:31]
    s_add_u32 s30, s8, 121600
    s_addc_u32 s31, s9, 0
    global_load_dword v205, v7, s[30:31]
    s_add_u32 s30, s8, 121856
    s_addc_u32 s31, s9, 0
    global_load_dword v206, v7, s[30:31]
    s_add_u32 s30, s8, 175104
    s_addc_u32 s31, s9, 0
    global_load_dword v207, v7, s[30:31]
    s_add_u32 s30, s8, 175360
    s_addc_u32 s31, s9, 0
    global_load_dword v208, v7, s[30:31]
    s_add_u32 s30, s8, 175616
    s_addc_u32 s31, s9, 0
    global_load_dword v209, v7, s[30:31]
    s_add_u32 s30, s8, 175872
    s_addc_u32 s31, s9, 0
    global_load_dword v210, v7, s[30:31]
    s_add_u32 s30, s8, 176128
    s_addc_u32 s31, s9, 0
    global_load_dword v211, v7, s[30:31]
    s_add_u32 s30, s8, 176384
    s_addc_u32 s31, s9, 0
    global_load_dword v212, v7, s[30:31]
    s_add_u32 s30, s8, 176640
    s_addc_u32 s31, s9, 0
    global_load_dword v213, v7, s[30:31]
    s_add_u32 s30, s8, 176896
    s_addc_u32 s31, s9, 0
    global_load_dword v214, v7, s[30:31]
    s_add_u32 s30, s8, 177152
    s_addc_u32 s31, s9, 0
    global_load_dword v215, v7, s[30:31]
    s_waitcnt vmcnt(0)
    v_add_f32 v100, v100, v109
    v_add_f32 v101, v101, v110
    v_add_f32 v102, v102, v111
    v_add_f32 v103, v103, v112
    v_add_f32 v104, v104, v113
    v_add_f32 v105, v105, v114
    v_add_f32 v106, v106, v115
    v_add_f32 v107, v107, v116
    v_add_f32 v108, v108, v117
    v_add_f32 v100, v100, v118
    v_add_f32 v101, v101, v119
    v_add_f32 v102, v102, v120
    v_add_f32 v103, v103, v121
    v_add_f32 v104, v104, v122
    v_add_f32 v105, v105, v123
    v_add_f32 v106, v106, v124
    v_add_f32 v107, v107, v125
    v_add_f32 v108, v108, v126
    v_add_f32 v100, v100, v127
    v_add_f32 v101, v101, v128
    v_add_f32 v102, v102, v129
    v_add_f32 v103, v103, v130
    v_add_f32 v104, v104, v131
    v_add_f32 v105, v105, v132
    v_add_f32 v106, v106, v133
    v_add_f32 v107, v107, v134
    v_add_f32 v108, v108, v135
    v_add_f32 v140, v140, v149
    v_add_f32 v141, v141, v150
    v_add_f32 v142, v142, v151
    v_add_f32 v143, v143, v152
    v_add_f32 v144, v144, v153
    v_add_f32 v145, v145, v154
    v_add_f32 v146, v146, v155
    v_add_f32 v147, v147, v156
    v_add_f32 v148, v148, v157
    v_add_f32 v140, v140, v158
    v_add_f32 v141, v141, v159
    v_add_f32 v142, v142, v160
    v_add_f32 v143, v143, v161
    v_add_f32 v144, v144, v162
    v_add_f32 v145, v145, v163
    v_add_f32 v146, v146, v164
    v_add_f32 v147, v147, v165
    v_add_f32 v148, v148, v166
    v_add_f32 v140, v140, v167
    v_add_f32 v141, v141, v168
    v_add_f32 v142, v142, v169
    v_add_f32 v143, v143, v170
    v_add_f32 v144, v144, v171
    v_add_f32 v145, v145, v172
    v_add_f32 v146, v146, v173
    v_add_f32 v147, v147, v174
    v_add_f32 v148, v148, v175
    v_add_f32 v180, v180, v189
    v_add_f32 v181, v181, v190
    v_add_f32 v182, v182, v191
    v_add_f32 v183, v183, v192
    v_add_f32 v184, v184, v193
    v_add_f32 v185, v185, v194
    v_add_f32 v186, v186, v195
    v_add_f32 v187, v187, v196
    v_add_f32 v188, v188, v197
    v_add_f32 v180, v180, v198
    v_add_f32 v181, v181, v199
    v_add_f32 v182, v182, v200
    v_add_f32 v183, v183, v201
    v_add_f32 v184, v184, v202
    v_add_f32 v185, v185, v203
    v_add_f32 v186, v186, v204
    v_add_f32 v187, v187, v205
    v_add_f32 v188, v188, v206
    v_add_f32 v180, v180, v207
    v_add_f32 v181, v181, v208
    v_add_f32 v182, v182, v209
    v_add_f32 v183, v183, v210
    v_add_f32 v184, v184, v211
    v_add_f32 v185, v185, v212
    v_add_f32 v186, v186, v213
    v_add_f32 v187, v187, v214
    v_add_f32 v188, v188, v215
    v_lshlrev_b32 v32, 16, v32
    v_fmac_f32 v32, v100, v44
    v_lshlrev_b32 v33, 16, v33
    v_fmac_f32 v33, v101, v45
    v_lshlrev_b32 v34, 16, v34
    v_fmac_f32 v34, v102, v46
    v_lshlrev_b32 v35, 16, v35
    v_fmac_f32 v35, v103, v47
    v_lshlrev_b32 v36, 16, v36
    v_fmac_f32 v36, v104, v48
    v_lshlrev_b32 v37, 16, v37
    v_fmac_f32 v37, v105, v49
    v_lshlrev_b32 v38, 16, v38
    v_fmac_f32 v38, v106, v50
    v_lshlrev_b32 v39, 16, v39
    v_fmac_f32 v39, v107, v51
    v_lshlrev_b32 v40, 16, v40
    v_fmac_f32 v40, v108, v52
    v_add_f32 v60, v32, v33
    v_add_f32 v60, v60, v34
    v_add_f32 v60, v60, v35
    v_add_f32 v60, v60, v36
    v_add_f32 v60, v60, v37
    v_add_f32 v60, v60, v38
    v_add_f32 v60, v60, v39
    v_add_f32 v60, v60, v40
    s_nop 1
    v_add_f32_dpp v60, v60, v60 quad_perm:[1,0,3,2] row_mask:0xf bank_mask:0xf
    s_nop 1
    v_add_f32_dpp v60, v60, v60 quad_perm:[2,3,0,1] row_mask:0xf bank_mask:0xf
    s_nop 1
    v_add_f32_dpp v60, v60, v60 row_half_mirror row_mask:0xf bank_mask:0xf
    s_nop 1
    v_add_f32_dpp v60, v60, v60 row_mirror row_mask:0xf bank_mask:0xf
    s_nop 1
    v_readlane_b32 s40, v60, 0
    v_readlane_b32 s41, v60, 16
    v_readlane_b32 s42, v60, 32
    v_readlane_b32 s43, v60, 48
    s_nop 3
    v_mov_b32 v60, s40
    v_add_f32 v60, s41, v60
    v_add_f32 v60, s42, v60
    v_add_f32 v60, s43, v60
    v_mul_f32 v60, 0x3ae38e39, v60
    v_sub_f32 v32, v32, v60
    v_sub_f32 v33, v33, v60
    v_sub_f32 v34, v34, v60
    v_sub_f32 v35, v35, v60
    v_sub_f32 v36, v36, v60
    v_sub_f32 v37, v37, v60
    v_sub_f32 v38, v38, v60
    v_sub_f32 v39, v39, v60
    v_sub_f32 v40, v40, v60
    v_mul_f32 v60, v32, v32
    v_fmac_f32 v60, v33, v33
    v_fmac_f32 v60, v34, v34
    v_fmac_f32 v60, v35, v35
    v_fmac_f32 v60, v36, v36
    v_fmac_f32 v60, v37, v37
    v_fmac_f32 v60, v38, v38
    v_fmac_f32 v60, v39, v39
    v_fmac_f32 v60, v40, v40
    s_nop 1
    v_add_f32_dpp v60, v60, v60 quad_perm:[1,0,3,2] row_mask:0xf bank_mask:0xf
    s_nop 1
    v_add_f32_dpp v60, v60, v60 quad_perm:[2,3,0,1] row_mask:0xf bank_mask:0xf
    s_nop 1
    v_add_f32_dpp v60, v60, v60 row_half_mirror row_mask:0xf bank_mask:0xf
    s_nop 1
    v_add_f32_dpp v60, v60, v60 row_mirror row_mask:0xf bank_mask:0xf
    s_nop 1
    v_readlane_b32 s40, v60, 0
    v_readlane_b32 s41, v60, 16
    v_readlane_b32 s42, v60, 32
    v_readlane_b32 s43, v60, 48
    s_nop 3
    v_mov_b32 v60, s40
    v_add_f32 v60, s41, v60
    v_add_f32 v60, s42, v60
    v_add_f32 v60, s43, v60
    v_mov_b32 v61, 0x3727c5ac
    v_fmac_f32 v61, 0x3ae38e39, v60
    v_rsq_f32 v61, v61
    s_nop 0
    v_mul_f32 v32, v32, v61
    v_mul_f32 v33, v33, v61
    v_mul_f32 v34, v34, v61
    v_mul_f32 v35, v35, v61
    v_mul_f32 v36, v36, v61
    v_mul_f32 v37, v37, v61
    v_mul_f32 v38, v38, v61
    v_mul_f32 v39, v39, v61
    v_mul_f32 v40, v40, v61
    v_add_f32 v180, 1.0, v180
    v_fma_f32 v32, v32, v180, v140
    v_add_f32 v181, 1.0, v181
    v_fma_f32 v33, v33, v181, v141
    v_add_f32 v182, 1.0, v182
    v_fma_f32 v34, v34, v182, v142
    v_add_f32 v183, 1.0, v183
    v_fma_f32 v35, v35, v183, v143
    v_add_f32 v184, 1.0, v184
    v_fma_f32 v36, v36, v184, v144
    v_add_f32 v185, 1.0, v185
    v_fma_f32 v37, v37, v185, v145
    v_add_f32 v186, 1.0, v186
    v_fma_f32 v38, v38, v186, v146
    v_add_f32 v187, 1.0, v187
    v_fma_f32 v39, v39, v187, v147
    v_add_f32 v188, 1.0, v188
    v_fma_f32 v40, v40, v188, v148
    v_lshlrev_b32 v7, 4, v6
    v_lshl_add_u32 v7, v5, 2, v7
    ds_write_b32 v7, v32 offset:0
    ds_write_b32 v7, v33 offset:1024
    ds_write_b32 v7, v34 offset:2048
    ds_write_b32 v7, v35 offset:3072
    ds_write_b32 v7, v36 offset:4096
    ds_write_b32 v7, v37 offset:5120
    ds_write_b32 v7, v38 offset:6144
    ds_write_b32 v7, v39 offset:7168
    ds_write_b32 v7, v40 offset:8192
k5_skip1:
    s_mov_b64 exec, s[34:35]
    v_lshrrev_b32 v4, 2, v0
    v_and_b32 v7, 3, v0
    s_mov_b32 s27, 9216
    v_mul_lo_u32 v3, v4, s27
    v_lshl_add_u32 v3, v7, 4, v3
    s_lshl_b32 s20, s2, 6
    s_add_u32 s10, s10, s20
    s_addc_u32 s11, s11, 0
    s_add_u32 s12, s12, s20
    s_addc_u32 s13, s13, 0
    global_load_dwordx4 v[64:67], v3, s[10:11] nt
    global_load_dwordx4 v[96:99], v3, s[12:13] nt
    s_add_u32 s10, s10, 663552
    s_addc_u32 s11, s11, 0
    s_add_u32 s12, s12, 663552
    s_addc_u32 s13, s13, 0
    global_load_dwordx4 v[68:71], v3, s[10:11] nt
    global_load_dwordx4 v[100:103], v3, s[12:13] nt
    s_add_u32 s10, s10, 663552
    s_addc_u32 s11, s11, 0
    s_add_u32 s12, s12, 663552
    s_addc_u32 s13, s13, 0
    global_load_dwordx4 v[72:75], v3, s[10:11] nt
    global_load_dwordx4 v[104:107], v3, s[12:13] nt
    s_add_u32 s10, s10, 663552
    s_addc_u32 s11, s11, 0
    s_add_u32 s12, s12, 663552
    s_addc_u32 s13, s13, 0
    global_load_dwordx4 v[76:79], v3, s[10:11] nt
    global_load_dwordx4 v[108:111], v3, s[12:13] nt
    s_add_u32 s10, s10, 663552
    s_addc_u32 s11, s11, 0
    s_add_u32 s12, s12, 663552
    s_addc_u32 s13, s13, 0
    global_load_dwordx4 v[80:83], v3, s[10:11] nt
    global_load_dwordx4 v[112:115], v3, s[12:13] nt
    s_add_u32 s10, s10, 663552
    s_addc_u32 s11, s11, 0
    s_add_u32 s12, s12, 663552
    s_addc_u32 s13, s13, 0
    global_load_dwordx4 v[84:87], v3, s[10:11] nt
    global_load_dwordx4 v[116:119], v3, s[12:13] nt
    s_add_u32 s10, s10, 663552
    s_addc_u32 s11, s11, 0
    s_add_u32 s12, s12, 663552
    s_addc_u32 s13, s13, 0
    global_load_dwordx4 v[88:91], v3, s[10:11] nt
    global_load_dwordx4 v[120:123], v3, s[12:13] nt
    s_add_u32 s10, s10, 663552
    s_addc_u32 s11, s11, 0
    s_add_u32 s12, s12, 663552
    s_addc_u32 s13, s13, 0
    global_load_dwordx4 v[92:95], v3, s[10:11] nt
    global_load_dwordx4 v[124:127], v3, s[12:13] nt
    s_waitcnt lgkmcnt(0)
    s_barrier
    v_lshlrev_b32 v3, 4, v4
    ds_read_b128 v[32:35], v3 offset:0
    ds_read_b128 v[36:39], v3 offset:1152
    ds_read_b128 v[40:43], v3 offset:2304
    ds_read_b128 v[44:47], v3 offset:3456
    ds_read_b128 v[48:51], v3 offset:4608
    ds_read_b128 v[52:55], v3 offset:5760
    ds_read_b128 v[56:59], v3 offset:6912
    ds_read_b128 v[60:63], v3 offset:8064
    s_waitcnt lgkmcnt(0)
    s_waitcnt vmcnt(15)
    v_lshlrev_b32 v250, 16, v64
    v_and_b32 v251, 0xffff0000, v64
    v_mul_f32 v128, v32, v250
    v_mul_f32 v129, v32, v251
    v_mul_f32 v136, v33, v250
    v_mul_f32 v137, v33, v251
    v_mul_f32 v144, v34, v250
    v_mul_f32 v145, v34, v251
    v_mul_f32 v152, v35, v250
    v_mul_f32 v153, v35, v251
    v_lshlrev_b32 v250, 16, v65
    v_and_b32 v251, 0xffff0000, v65
    v_mul_f32 v130, v32, v250
    v_mul_f32 v131, v32, v251
    v_mul_f32 v138, v33, v250
    v_mul_f32 v139, v33, v251
    v_mul_f32 v146, v34, v250
    v_mul_f32 v147, v34, v251
    v_mul_f32 v154, v35, v250
    v_mul_f32 v155, v35, v251
    v_lshlrev_b32 v250, 16, v66
    v_and_b32 v251, 0xffff0000, v66
    v_mul_f32 v132, v32, v250
    v_mul_f32 v133, v32, v251
    v_mul_f32 v140, v33, v250
    v_mul_f32 v141, v33, v251
    v_mul_f32 v148, v34, v250
    v_mul_f32 v149, v34, v251
    v_mul_f32 v156, v35, v250
    v_mul_f32 v157, v35, v251
    v_lshlrev_b32 v250, 16, v67
    v_and_b32 v251, 0xffff0000, v67
    v_mul_f32 v134, v32, v250
    v_mul_f32 v135, v32, v251
    v_mul_f32 v142, v33, v250
    v_mul_f32 v143, v33, v251
    v_mul_f32 v150, v34, v250
    v_mul_f32 v151, v34, v251
    v_mul_f32 v158, v35, v250
    v_mul_f32 v159, v35, v251
    s_waitcnt vmcnt(14)
    v_lshlrev_b32 v250, 16, v96
    v_and_b32 v251, 0xffff0000, v96
    v_mul_f32 v160, v32, v250
    v_mul_f32 v161, v32, v251
    v_mul_f32 v168, v33, v250
    v_mul_f32 v169, v33, v251
    v_mul_f32 v176, v34, v250
    v_mul_f32 v177, v34, v251
    v_mul_f32 v184, v35, v250
    v_mul_f32 v185, v35, v251
    v_lshlrev_b32 v250, 16, v97
    v_and_b32 v251, 0xffff0000, v97
    v_mul_f32 v162, v32, v250
    v_mul_f32 v163, v32, v251
    v_mul_f32 v170, v33, v250
    v_mul_f32 v171, v33, v251
    v_mul_f32 v178, v34, v250
    v_mul_f32 v179, v34, v251
    v_mul_f32 v186, v35, v250
    v_mul_f32 v187, v35, v251
    v_lshlrev_b32 v250, 16, v98
    v_and_b32 v251, 0xffff0000, v98
    v_mul_f32 v164, v32, v250
    v_mul_f32 v165, v32, v251
    v_mul_f32 v172, v33, v250
    v_mul_f32 v173, v33, v251
    v_mul_f32 v180, v34, v250
    v_mul_f32 v181, v34, v251
    v_mul_f32 v188, v35, v250
    v_mul_f32 v189, v35, v251
    v_lshlrev_b32 v250, 16, v99
    v_and_b32 v251, 0xffff0000, v99
    v_mul_f32 v166, v32, v250
    v_mul_f32 v167, v32, v251
    v_mul_f32 v174, v33, v250
    v_mul_f32 v175, v33, v251
    v_mul_f32 v182, v34, v250
    v_mul_f32 v183, v34, v251
    v_mul_f32 v190, v35, v250
    v_mul_f32 v191, v35, v251
    s_waitcnt vmcnt(13)
    v_lshlrev_b32 v250, 16, v68
    v_and_b32 v251, 0xffff0000, v68
    v_fmac_f32 v128, v36, v250
    v_fmac_f32 v129, v36, v251
    v_fmac_f32 v136, v37, v250
    v_fmac_f32 v137, v37, v251
    v_fmac_f32 v144, v38, v250
    v_fmac_f32 v145, v38, v251
    v_fmac_f32 v152, v39, v250
    v_fmac_f32 v153, v39, v251
    v_lshlrev_b32 v250, 16, v69
    v_and_b32 v251, 0xffff0000, v69
    v_fmac_f32 v130, v36, v250
    v_fmac_f32 v131, v36, v251
    v_fmac_f32 v138, v37, v250
    v_fmac_f32 v139, v37, v251
    v_fmac_f32 v146, v38, v250
    v_fmac_f32 v147, v38, v251
    v_fmac_f32 v154, v39, v250
    v_fmac_f32 v155, v39, v251
    v_lshlrev_b32 v250, 16, v70
    v_and_b32 v251, 0xffff0000, v70
    v_fmac_f32 v132, v36, v250
    v_fmac_f32 v133, v36, v251
    v_fmac_f32 v140, v37, v250
    v_fmac_f32 v141, v37, v251
    v_fmac_f32 v148, v38, v250
    v_fmac_f32 v149, v38, v251
    v_fmac_f32 v156, v39, v250
    v_fmac_f32 v157, v39, v251
    v_lshlrev_b32 v250, 16, v71
    v_and_b32 v251, 0xffff0000, v71
    v_fmac_f32 v134, v36, v250
    v_fmac_f32 v135, v36, v251
    v_fmac_f32 v142, v37, v250
    v_fmac_f32 v143, v37, v251
    v_fmac_f32 v150, v38, v250
    v_fmac_f32 v151, v38, v251
    v_fmac_f32 v158, v39, v250
    v_fmac_f32 v159, v39, v251
    s_waitcnt vmcnt(12)
    v_lshlrev_b32 v250, 16, v100
    v_and_b32 v251, 0xffff0000, v100
    v_fmac_f32 v160, v36, v250
    v_fmac_f32 v161, v36, v251
    v_fmac_f32 v168, v37, v250
    v_fmac_f32 v169, v37, v251
    v_fmac_f32 v176, v38, v250
    v_fmac_f32 v177, v38, v251
    v_fmac_f32 v184, v39, v250
    v_fmac_f32 v185, v39, v251
    v_lshlrev_b32 v250, 16, v101
    v_and_b32 v251, 0xffff0000, v101
    v_fmac_f32 v162, v36, v250
    v_fmac_f32 v163, v36, v251
    v_fmac_f32 v170, v37, v250
    v_fmac_f32 v171, v37, v251
    v_fmac_f32 v178, v38, v250
    v_fmac_f32 v179, v38, v251
    v_fmac_f32 v186, v39, v250
    v_fmac_f32 v187, v39, v251
    v_lshlrev_b32 v250, 16, v102
    v_and_b32 v251, 0xffff0000, v102
    v_fmac_f32 v164, v36, v250
    v_fmac_f32 v165, v36, v251
    v_fmac_f32 v172, v37, v250
    v_fmac_f32 v173, v37, v251
    v_fmac_f32 v180, v38, v250
    v_fmac_f32 v181, v38, v251
    v_fmac_f32 v188, v39, v250
    v_fmac_f32 v189, v39, v251
    v_lshlrev_b32 v250, 16, v103
    v_and_b32 v251, 0xffff0000, v103
    v_fmac_f32 v166, v36, v250
    v_fmac_f32 v167, v36, v251
    v_fmac_f32 v174, v37, v250
    v_fmac_f32 v175, v37, v251
    v_fmac_f32 v182, v38, v250
    v_fmac_f32 v183, v38, v251
    v_fmac_f32 v190, v39, v250
    v_fmac_f32 v191, v39, v251
    s_waitcnt vmcnt(11)
    v_lshlrev_b32 v250, 16, v72
    v_and_b32 v251, 0xffff0000, v72
    v_fmac_f32 v128, v40, v250
    v_fmac_f32 v129, v40, v251
    v_fmac_f32 v136, v41, v250
    v_fmac_f32 v137, v41, v251
    v_fmac_f32 v144, v42, v250
    v_fmac_f32 v145, v42, v251
    v_fmac_f32 v152, v43, v250
    v_fmac_f32 v153, v43, v251
    v_lshlrev_b32 v250, 16, v73
    v_and_b32 v251, 0xffff0000, v73
    v_fmac_f32 v130, v40, v250
    v_fmac_f32 v131, v40, v251
    v_fmac_f32 v138, v41, v250
    v_fmac_f32 v139, v41, v251
    v_fmac_f32 v146, v42, v250
    v_fmac_f32 v147, v42, v251
    v_fmac_f32 v154, v43, v250
    v_fmac_f32 v155, v43, v251
    v_lshlrev_b32 v250, 16, v74
    v_and_b32 v251, 0xffff0000, v74
    v_fmac_f32 v132, v40, v250
    v_fmac_f32 v133, v40, v251
    v_fmac_f32 v140, v41, v250
    v_fmac_f32 v141, v41, v251
    v_fmac_f32 v148, v42, v250
    v_fmac_f32 v149, v42, v251
    v_fmac_f32 v156, v43, v250
    v_fmac_f32 v157, v43, v251
    v_lshlrev_b32 v250, 16, v75
    v_and_b32 v251, 0xffff0000, v75
    v_fmac_f32 v134, v40, v250
    v_fmac_f32 v135, v40, v251
    v_fmac_f32 v142, v41, v250
    v_fmac_f32 v143, v41, v251
    v_fmac_f32 v150, v42, v250
    v_fmac_f32 v151, v42, v251
    v_fmac_f32 v158, v43, v250
    v_fmac_f32 v159, v43, v251
    s_waitcnt vmcnt(10)
    v_lshlrev_b32 v250, 16, v104
    v_and_b32 v251, 0xffff0000, v104
    v_fmac_f32 v160, v40, v250
    v_fmac_f32 v161, v40, v251
    v_fmac_f32 v168, v41, v250
    v_fmac_f32 v169, v41, v251
    v_fmac_f32 v176, v42, v250
    v_fmac_f32 v177, v42, v251
    v_fmac_f32 v184, v43, v250
    v_fmac_f32 v185, v43, v251
    v_lshlrev_b32 v250, 16, v105
    v_and_b32 v251, 0xffff0000, v105
    v_fmac_f32 v162, v40, v250
    v_fmac_f32 v163, v40, v251
    v_fmac_f32 v170, v41, v250
    v_fmac_f32 v171, v41, v251
    v_fmac_f32 v178, v42, v250
    v_fmac_f32 v179, v42, v251
    v_fmac_f32 v186, v43, v250
    v_fmac_f32 v187, v43, v251
    v_lshlrev_b32 v250, 16, v106
    v_and_b32 v251, 0xffff0000, v106
    v_fmac_f32 v164, v40, v250
    v_fmac_f32 v165, v40, v251
    v_fmac_f32 v172, v41, v250
    v_fmac_f32 v173, v41, v251
    v_fmac_f32 v180, v42, v250
    v_fmac_f32 v181, v42, v251
    v_fmac_f32 v188, v43, v250
    v_fmac_f32 v189, v43, v251
    v_lshlrev_b32 v250, 16, v107
    v_and_b32 v251, 0xffff0000, v107
    v_fmac_f32 v166, v40, v250
    v_fmac_f32 v167, v40, v251
    v_fmac_f32 v174, v41, v250
    v_fmac_f32 v175, v41, v251
    v_fmac_f32 v182, v42, v250
    v_fmac_f32 v183, v42, v251
    v_fmac_f32 v190, v43, v250
    v_fmac_f32 v191, v43, v251
    s_waitcnt vmcnt(9)
    v_lshlrev_b32 v250, 16, v76
    v_and_b32 v251, 0xffff0000, v76
    v_fmac_f32 v128, v44, v250
    v_fmac_f32 v129, v44, v251
    v_fmac_f32 v136, v45, v250
    v_fmac_f32 v137, v45, v251
    v_fmac_f32 v144, v46, v250
    v_fmac_f32 v145, v46, v251
    v_fmac_f32 v152, v47, v250
    v_fmac_f32 v153, v47, v251
    v_lshlrev_b32 v250, 16, v77
    v_and_b32 v251, 0xffff0000, v77
    v_fmac_f32 v130, v44, v250
    v_fmac_f32 v131, v44, v251
    v_fmac_f32 v138, v45, v250
    v_fmac_f32 v139, v45, v251
    v_fmac_f32 v146, v46, v250
    v_fmac_f32 v147, v46, v251
    v_fmac_f32 v154, v47, v250
    v_fmac_f32 v155, v47, v251
    v_lshlrev_b32 v250, 16, v78
    v_and_b32 v251, 0xffff0000, v78
    v_fmac_f32 v132, v44, v250
    v_fmac_f32 v133, v44, v251
    v_fmac_f32 v140, v45, v250
    v_fmac_f32 v141, v45, v251
    v_fmac_f32 v148, v46, v250
    v_fmac_f32 v149, v46, v251
    v_fmac_f32 v156, v47, v250
    v_fmac_f32 v157, v47, v251
    v_lshlrev_b32 v250, 16, v79
    v_and_b32 v251, 0xffff0000, v79
    v_fmac_f32 v134, v44, v250
    v_fmac_f32 v135, v44, v251
    v_fmac_f32 v142, v45, v250
    v_fmac_f32 v143, v45, v251
    v_fmac_f32 v150, v46, v250
    v_fmac_f32 v151, v46, v251
    v_fmac_f32 v158, v47, v250
    v_fmac_f32 v159, v47, v251
    s_waitcnt vmcnt(8)
    v_lshlrev_b32 v250, 16, v108
    v_and_b32 v251, 0xffff0000, v108
    v_fmac_f32 v160, v44, v250
    v_fmac_f32 v161, v44, v251
    v_fmac_f32 v168, v45, v250
    v_fmac_f32 v169, v45, v251
    v_fmac_f32 v176, v46, v250
    v_fmac_f32 v177, v46, v251
    v_fmac_f32 v184, v47, v250
    v_fmac_f32 v185, v47, v251
    v_lshlrev_b32 v250, 16, v109
    v_and_b32 v251, 0xffff0000, v109
    v_fmac_f32 v162, v44, v250
    v_fmac_f32 v163, v44, v251
    v_fmac_f32 v170, v45, v250
    v_fmac_f32 v171, v45, v251
    v_fmac_f32 v178, v46, v250
    v_fmac_f32 v179, v46, v251
    v_fmac_f32 v186, v47, v250
    v_fmac_f32 v187, v47, v251
    v_lshlrev_b32 v250, 16, v110
    v_and_b32 v251, 0xffff0000, v110
    v_fmac_f32 v164, v44, v250
    v_fmac_f32 v165, v44, v251
    v_fmac_f32 v172, v45, v250
    v_fmac_f32 v173, v45, v251
    v_fmac_f32 v180, v46, v250
    v_fmac_f32 v181, v46, v251
    v_fmac_f32 v188, v47, v250
    v_fmac_f32 v189, v47, v251
    v_lshlrev_b32 v250, 16, v111
    v_and_b32 v251, 0xffff0000, v111
    v_fmac_f32 v166, v44, v250
    v_fmac_f32 v167, v44, v251
    v_fmac_f32 v174, v45, v250
    v_fmac_f32 v175, v45, v251
    v_fmac_f32 v182, v46, v250
    v_fmac_f32 v183, v46, v251
    v_fmac_f32 v190, v47, v250
    v_fmac_f32 v191, v47, v251
    s_waitcnt vmcnt(7)
    v_lshlrev_b32 v250, 16, v80
    v_and_b32 v251, 0xffff0000, v80
    v_fmac_f32 v128, v48, v250
    v_fmac_f32 v129, v48, v251
    v_fmac_f32 v136, v49, v250
    v_fmac_f32 v137, v49, v251
    v_fmac_f32 v144, v50, v250
    v_fmac_f32 v145, v50, v251
    v_fmac_f32 v152, v51, v250
    v_fmac_f32 v153, v51, v251
    v_lshlrev_b32 v250, 16, v81
    v_and_b32 v251, 0xffff0000, v81
    v_fmac_f32 v130, v48, v250
    v_fmac_f32 v131, v48, v251
    v_fmac_f32 v138, v49, v250
    v_fmac_f32 v139, v49, v251
    v_fmac_f32 v146, v50, v250
    v_fmac_f32 v147, v50, v251
    v_fmac_f32 v154, v51, v250
    v_fmac_f32 v155, v51, v251
    v_lshlrev_b32 v250, 16, v82
    v_and_b32 v251, 0xffff0000, v82
    v_fmac_f32 v132, v48, v250
    v_fmac_f32 v133, v48, v251
    v_fmac_f32 v140, v49, v250
    v_fmac_f32 v141, v49, v251
    v_fmac_f32 v148, v50, v250
    v_fmac_f32 v149, v50, v251
    v_fmac_f32 v156, v51, v250
    v_fmac_f32 v157, v51, v251
    v_lshlrev_b32 v250, 16, v83
    v_and_b32 v251, 0xffff0000, v83
    v_fmac_f32 v134, v48, v250
    v_fmac_f32 v135, v48, v251
    v_fmac_f32 v142, v49, v250
    v_fmac_f32 v143, v49, v251
    v_fmac_f32 v150, v50, v250
    v_fmac_f32 v151, v50, v251
    v_fmac_f32 v158, v51, v250
    v_fmac_f32 v159, v51, v251
    s_waitcnt vmcnt(6)
    v_lshlrev_b32 v250, 16, v112
    v_and_b32 v251, 0xffff0000, v112
    v_fmac_f32 v160, v48, v250
    v_fmac_f32 v161, v48, v251
    v_fmac_f32 v168, v49, v250
    v_fmac_f32 v169, v49, v251
    v_fmac_f32 v176, v50, v250
    v_fmac_f32 v177, v50, v251
    v_fmac_f32 v184, v51, v250
    v_fmac_f32 v185, v51, v251
    v_lshlrev_b32 v250, 16, v113
    v_and_b32 v251, 0xffff0000, v113
    v_fmac_f32 v162, v48, v250
    v_fmac_f32 v163, v48, v251
    v_fmac_f32 v170, v49, v250
    v_fmac_f32 v171, v49, v251
    v_fmac_f32 v178, v50, v250
    v_fmac_f32 v179, v50, v251
    v_fmac_f32 v186, v51, v250
    v_fmac_f32 v187, v51, v251
    v_lshlrev_b32 v250, 16, v114
    v_and_b32 v251, 0xffff0000, v114
    v_fmac_f32 v164, v48, v250
    v_fmac_f32 v165, v48, v251
    v_fmac_f32 v172, v49, v250
    v_fmac_f32 v173, v49, v251
    v_fmac_f32 v180, v50, v250
    v_fmac_f32 v181, v50, v251
    v_fmac_f32 v188, v51, v250
    v_fmac_f32 v189, v51, v251
    v_lshlrev_b32 v250, 16, v115
    v_and_b32 v251, 0xffff0000, v115
    v_fmac_f32 v166, v48, v250
    v_fmac_f32 v167, v48, v251
    v_fmac_f32 v174, v49, v250
    v_fmac_f32 v175, v49, v251
    v_fmac_f32 v182, v50, v250
    v_fmac_f32 v183, v50, v251
    v_fmac_f32 v190, v51, v250
    v_fmac_f32 v191, v51, v251
    s_waitcnt vmcnt(5)
    v_lshlrev_b32 v250, 16, v84
    v_and_b32 v251, 0xffff0000, v84
    v_fmac_f32 v128, v52, v250
    v_fmac_f32 v129, v52, v251
    v_fmac_f32 v136, v53, v250
    v_fmac_f32 v137, v53, v251
    v_fmac_f32 v144, v54, v250
    v_fmac_f32 v145, v54, v251
    v_fmac_f32 v152, v55, v250
    v_fmac_f32 v153, v55, v251
    v_lshlrev_b32 v250, 16, v85
    v_and_b32 v251, 0xffff0000, v85
    v_fmac_f32 v130, v52, v250
    v_fmac_f32 v131, v52, v251
    v_fmac_f32 v138, v53, v250
    v_fmac_f32 v139, v53, v251
    v_fmac_f32 v146, v54, v250
    v_fmac_f32 v147, v54, v251
    v_fmac_f32 v154, v55, v250
    v_fmac_f32 v155, v55, v251
    v_lshlrev_b32 v250, 16, v86
    v_and_b32 v251, 0xffff0000, v86
    v_fmac_f32 v132, v52, v250
    v_fmac_f32 v133, v52, v251
    v_fmac_f32 v140, v53, v250
    v_fmac_f32 v141, v53, v251
    v_fmac_f32 v148, v54, v250
    v_fmac_f32 v149, v54, v251
    v_fmac_f32 v156, v55, v250
    v_fmac_f32 v157, v55, v251
    v_lshlrev_b32 v250, 16, v87
    v_and_b32 v251, 0xffff0000, v87
    v_fmac_f32 v134, v52, v250
    v_fmac_f32 v135, v52, v251
    v_fmac_f32 v142, v53, v250
    v_fmac_f32 v143, v53, v251
    v_fmac_f32 v150, v54, v250
    v_fmac_f32 v151, v54, v251
    v_fmac_f32 v158, v55, v250
    v_fmac_f32 v159, v55, v251
    s_waitcnt vmcnt(4)
    v_lshlrev_b32 v250, 16, v116
    v_and_b32 v251, 0xffff0000, v116
    v_fmac_f32 v160, v52, v250
    v_fmac_f32 v161, v52, v251
    v_fmac_f32 v168, v53, v250
    v_fmac_f32 v169, v53, v251
    v_fmac_f32 v176, v54, v250
    v_fmac_f32 v177, v54, v251
    v_fmac_f32 v184, v55, v250
    v_fmac_f32 v185, v55, v251
    v_lshlrev_b32 v250, 16, v117
    v_and_b32 v251, 0xffff0000, v117
    v_fmac_f32 v162, v52, v250
    v_fmac_f32 v163, v52, v251
    v_fmac_f32 v170, v53, v250
    v_fmac_f32 v171, v53, v251
    v_fmac_f32 v178, v54, v250
    v_fmac_f32 v179, v54, v251
    v_fmac_f32 v186, v55, v250
    v_fmac_f32 v187, v55, v251
    v_lshlrev_b32 v250, 16, v118
    v_and_b32 v251, 0xffff0000, v118
    v_fmac_f32 v164, v52, v250
    v_fmac_f32 v165, v52, v251
    v_fmac_f32 v172, v53, v250
    v_fmac_f32 v173, v53, v251
    v_fmac_f32 v180, v54, v250
    v_fmac_f32 v181, v54, v251
    v_fmac_f32 v188, v55, v250
    v_fmac_f32 v189, v55, v251
    v_lshlrev_b32 v250, 16, v119
    v_and_b32 v251, 0xffff0000, v119
    v_fmac_f32 v166, v52, v250
    v_fmac_f32 v167, v52, v251
    v_fmac_f32 v174, v53, v250
    v_fmac_f32 v175, v53, v251
    v_fmac_f32 v182, v54, v250
    v_fmac_f32 v183, v54, v251
    v_fmac_f32 v190, v55, v250
    v_fmac_f32 v191, v55, v251
    s_waitcnt vmcnt(3)
    v_lshlrev_b32 v250, 16, v88
    v_and_b32 v251, 0xffff0000, v88
    v_fmac_f32 v128, v56, v250
    v_fmac_f32 v129, v56, v251
    v_fmac_f32 v136, v57, v250
    v_fmac_f32 v137, v57, v251
    v_fmac_f32 v144, v58, v250
    v_fmac_f32 v145, v58, v251
    v_fmac_f32 v152, v59, v250
    v_fmac_f32 v153, v59, v251
    v_lshlrev_b32 v250, 16, v89
    v_and_b32 v251, 0xffff0000, v89
    v_fmac_f32 v130, v56, v250
    v_fmac_f32 v131, v56, v251
    v_fmac_f32 v138, v57, v250
    v_fmac_f32 v139, v57, v251
    v_fmac_f32 v146, v58, v250
    v_fmac_f32 v147, v58, v251
    v_fmac_f32 v154, v59, v250
    v_fmac_f32 v155, v59, v251
    v_lshlrev_b32 v250, 16, v90
    v_and_b32 v251, 0xffff0000, v90
    v_fmac_f32 v132, v56, v250
    v_fmac_f32 v133, v56, v251
    v_fmac_f32 v140, v57, v250
    v_fmac_f32 v141, v57, v251
    v_fmac_f32 v148, v58, v250
    v_fmac_f32 v149, v58, v251
    v_fmac_f32 v156, v59, v250
    v_fmac_f32 v157, v59, v251
    v_lshlrev_b32 v250, 16, v91
    v_and_b32 v251, 0xffff0000, v91
    v_fmac_f32 v134, v56, v250
    v_fmac_f32 v135, v56, v251
    v_fmac_f32 v142, v57, v250
    v_fmac_f32 v143, v57, v251
    v_fmac_f32 v150, v58, v250
    v_fmac_f32 v151, v58, v251
    v_fmac_f32 v158, v59, v250
    v_fmac_f32 v159, v59, v251
    s_waitcnt vmcnt(2)
    v_lshlrev_b32 v250, 16, v120
    v_and_b32 v251, 0xffff0000, v120
    v_fmac_f32 v160, v56, v250
    v_fmac_f32 v161, v56, v251
    v_fmac_f32 v168, v57, v250
    v_fmac_f32 v169, v57, v251
    v_fmac_f32 v176, v58, v250
    v_fmac_f32 v177, v58, v251
    v_fmac_f32 v184, v59, v250
    v_fmac_f32 v185, v59, v251
    v_lshlrev_b32 v250, 16, v121
    v_and_b32 v251, 0xffff0000, v121
    v_fmac_f32 v162, v56, v250
    v_fmac_f32 v163, v56, v251
    v_fmac_f32 v170, v57, v250
    v_fmac_f32 v171, v57, v251
    v_fmac_f32 v178, v58, v250
    v_fmac_f32 v179, v58, v251
    v_fmac_f32 v186, v59, v250
    v_fmac_f32 v187, v59, v251
    v_lshlrev_b32 v250, 16, v122
    v_and_b32 v251, 0xffff0000, v122
    v_fmac_f32 v164, v56, v250
    v_fmac_f32 v165, v56, v251
    v_fmac_f32 v172, v57, v250
    v_fmac_f32 v173, v57, v251
    v_fmac_f32 v180, v58, v250
    v_fmac_f32 v181, v58, v251
    v_fmac_f32 v188, v59, v250
    v_fmac_f32 v189, v59, v251
    v_lshlrev_b32 v250, 16, v123
    v_and_b32 v251, 0xffff0000, v123
    v_fmac_f32 v166, v56, v250
    v_fmac_f32 v167, v56, v251
    v_fmac_f32 v174, v57, v250
    v_fmac_f32 v175, v57, v251
    v_fmac_f32 v182, v58, v250
    v_fmac_f32 v183, v58, v251
    v_fmac_f32 v190, v59, v250
    v_fmac_f32 v191, v59, v251
    s_waitcnt vmcnt(1)
    v_lshlrev_b32 v250, 16, v92
    v_and_b32 v251, 0xffff0000, v92
    v_fmac_f32 v128, v60, v250
    v_fmac_f32 v129, v60, v251
    v_fmac_f32 v136, v61, v250
    v_fmac_f32 v137, v61, v251
    v_fmac_f32 v144, v62, v250
    v_fmac_f32 v145, v62, v251
    v_fmac_f32 v152, v63, v250
    v_fmac_f32 v153, v63, v251
    v_lshlrev_b32 v250, 16, v93
    v_and_b32 v251, 0xffff0000, v93
    v_fmac_f32 v130, v60, v250
    v_fmac_f32 v131, v60, v251
    v_fmac_f32 v138, v61, v250
    v_fmac_f32 v139, v61, v251
    v_fmac_f32 v146, v62, v250
    v_fmac_f32 v147, v62, v251
    v_fmac_f32 v154, v63, v250
    v_fmac_f32 v155, v63, v251
    v_lshlrev_b32 v250, 16, v94
    v_and_b32 v251, 0xffff0000, v94
    v_fmac_f32 v132, v60, v250
    v_fmac_f32 v133, v60, v251
    v_fmac_f32 v140, v61, v250
    v_fmac_f32 v141, v61, v251
    v_fmac_f32 v148, v62, v250
    v_fmac_f32 v149, v62, v251
    v_fmac_f32 v156, v63, v250
    v_fmac_f32 v157, v63, v251
    v_lshlrev_b32 v250, 16, v95
    v_and_b32 v251, 0xffff0000, v95
    v_fmac_f32 v134, v60, v250
    v_fmac_f32 v135, v60, v251
    v_fmac_f32 v142, v61, v250
    v_fmac_f32 v143, v61, v251
    v_fmac_f32 v150, v62, v250
    v_fmac_f32 v151, v62, v251
    v_fmac_f32 v158, v63, v250
    v_fmac_f32 v159, v63, v251
    s_waitcnt vmcnt(0)
    v_lshlrev_b32 v250, 16, v124
    v_and_b32 v251, 0xffff0000, v124
    v_fmac_f32 v160, v60, v250
    v_fmac_f32 v161, v60, v251
    v_fmac_f32 v168, v61, v250
    v_fmac_f32 v169, v61, v251
    v_fmac_f32 v176, v62, v250
    v_fmac_f32 v177, v62, v251
    v_fmac_f32 v184, v63, v250
    v_fmac_f32 v185, v63, v251
    v_lshlrev_b32 v250, 16, v125
    v_and_b32 v251, 0xffff0000, v125
    v_fmac_f32 v162, v60, v250
    v_fmac_f32 v163, v60, v251
    v_fmac_f32 v170, v61, v250
    v_fmac_f32 v171, v61, v251
    v_fmac_f32 v178, v62, v250
    v_fmac_f32 v179, v62, v251
    v_fmac_f32 v186, v63, v250
    v_fmac_f32 v187, v63, v251
    v_lshlrev_b32 v250, 16, v126
    v_and_b32 v251, 0xffff0000, v126
    v_fmac_f32 v164, v60, v250
    v_fmac_f32 v165, v60, v251
    v_fmac_f32 v172, v61, v250
    v_fmac_f32 v173, v61, v251
    v_fmac_f32 v180, v62, v250
    v_fmac_f32 v181, v62, v251
    v_fmac_f32 v188, v63, v250
    v_fmac_f32 v189, v63, v251
    v_lshlrev_b32 v250, 16, v127
    v_and_b32 v251, 0xffff0000, v127
    v_fmac_f32 v166, v60, v250
    v_fmac_f32 v167, v60, v251
    v_fmac_f32 v174, v61, v250
    v_fmac_f32 v175, v61, v251
    v_fmac_f32 v182, v62, v250
    v_fmac_f32 v183, v62, v251
    v_fmac_f32 v190, v63, v250
    v_fmac_f32 v191, v63, v251
    s_mul_i32 s20, s2, 36864
    s_add_u32 s14, s14, s20
    s_addc_u32 s15, s15, 0
    v_lshlrev_b32 v3, 4, v0
    global_load_dwordx4 v[64:67], v3, s[14:15] nt
    s_add_u32 s14, s14, 4608
    s_addc_u32 s15, s15, 0
    global_load_dwordx4 v[68:71], v3, s[14:15] nt
    s_add_u32 s14, s14, 4608
    s_addc_u32 s15, s15, 0
    global_load_dwordx4 v[72:75], v3, s[14:15] nt
    s_add_u32 s14, s14, 4608
    s_addc_u32 s15, s15, 0
    global_load_dwordx4 v[76:79], v3, s[14:15] nt
    s_add_u32 s14, s14, 4608
    s_addc_u32 s15, s15, 0
    global_load_dwordx4 v[80:83], v3, s[14:15] nt
    s_add_u32 s14, s14, 4608
    s_addc_u32 s15, s15, 0
    global_load_dwordx4 v[84:87], v3, s[14:15] nt
    s_add_u32 s14, s14, 4608
    s_addc_u32 s15, s15, 0
    global_load_dwordx4 v[88:91], v3, s[14:15] nt
    s_add_u32 s14, s14, 4608
    s_addc_u32 s15, s15, 0
    global_load_dwordx4 v[92:95], v3, s[14:15] nt
    v_lshlrev_b32 v3, 10, v4
    v_lshl_add_u32 v3, v7, 5, v3
    ds_write_b128 v3, v[128:131] offset:12288
    ds_write_b128 v3, v[132:135] offset:12304
    ds_write_b128 v3, v[136:139] offset:12416
    ds_write_b128 v3, v[140:143] offset:12432
    ds_write_b128 v3, v[144:147] offset:12544
    ds_write_b128 v3, v[148:151] offset:12560
    ds_write_b128 v3, v[152:155] offset:12672
    ds_write_b128 v3, v[156:159] offset:12688
    ds_write_b128 v3, v[160:163] offset:12800
    ds_write_b128 v3, v[164:167] offset:12816
    ds_write_b128 v3, v[168:171] offset:12928
    ds_write_b128 v3, v[172:175] offset:12944
    ds_write_b128 v3, v[176:179] offset:13056
    ds_write_b128 v3, v[180:183] offset:13072
    ds_write_b128 v3, v[184:187] offset:13184
    ds_write_b128 v3, v[188:191] offset:13200
    s_waitcnt lgkmcnt(0)
    s_barrier
    v_cmp_gt_u32 vcc, 256, v0
    s_and_saveexec_b64 s[34:35], vcc
    s_cbranch_execz k5_skip2
    v_lshlrev_b32 v3, 2, v0
    v_add_u32 v11, 49152, v3
    ds_read_b32 v128, v3 offset:12288
    ds_read_b32 v129, v3 offset:13312
    ds_read_b32 v130, v3 offset:14336
    ds_read_b32 v131, v3 offset:15360
    ds_read_b32 v132, v3 offset:16384
    ds_read_b32 v133, v3 offset:17408
    ds_read_b32 v134, v3 offset:18432
    ds_read_b32 v135, v3 offset:19456
    ds_read_b32 v136, v3 offset:20480
    ds_read_b32 v137, v3 offset:21504
    ds_read_b32 v138, v3 offset:22528
    ds_read_b32 v139, v3 offset:23552
    ds_read_b32 v140, v3 offset:24576
    ds_read_b32 v141, v3 offset:25600
    ds_read_b32 v142, v3 offset:26624
    ds_read_b32 v143, v3 offset:27648
    ds_read_b32 v144, v3 offset:28672
    ds_read_b32 v145, v3 offset:29696
    ds_read_b32 v146, v3 offset:30720
    ds_read_b32 v147, v3 offset:31744
    ds_read_b32 v148, v3 offset:32768
    ds_read_b32 v149, v3 offset:33792
    ds_read_b32 v150, v3 offset:34816
    ds_read_b32 v151, v3 offset:35840
    ds_read_b32 v152, v3 offset:36864
    ds_read_b32 v153, v3 offset:37888
    ds_read_b32 v154, v3 offset:38912
    ds_read_b32 v155, v3 offset:39936
    ds_read_b32 v156, v3 offset:40960
    ds_read_b32 v157, v3 offset:41984
    ds_read_b32 v158, v3 offset:43008
    ds_read_b32 v159, v3 offset:44032
    ds_read_b32 v160, v3 offset:45056
    ds_read_b32 v161, v3 offset:46080
    ds_read_b32 v162, v3 offset:47104
    ds_read_b32 v163, v3 offset:48128
    ds_read_b32 v164, v11 offset:0
    ds_read_b32 v165, v11 offset:1024
    ds_read_b32 v166, v11 offset:2048
    ds_read_b32 v167, v11 offset:3072
    ds_read_b32 v168, v11 offset:4096
    ds_read_b32 v169, v11 offset:5120
    ds_read_b32 v170, v11 offset:6144
    ds_read_b32 v171, v11 offset:7168
    ds_read_b32 v172, v11 offset:8192
    ds_read_b32 v173, v11 offset:9216
    ds_read_b32 v174, v11 offset:10240
    ds_read_b32 v175, v11 offset:11264
    ds_read_b32 v176, v11 offset:12288
    ds_read_b32 v177, v11 offset:13312
    ds_read_b32 v178, v11 offset:14336
    ds_read_b32 v179, v11 offset:15360
    ds_read_b32 v180, v11 offset:16384
    ds_read_b32 v181, v11 offset:17408
    ds_read_b32 v182, v11 offset:18432
    ds_read_b32 v183, v11 offset:19456
    ds_read_b32 v184, v11 offset:20480
    ds_read_b32 v185, v11 offset:21504
    ds_read_b32 v186, v11 offset:22528
    ds_read_b32 v187, v11 offset:23552
    ds_read_b32 v188, v11 offset:24576
    ds_read_b32 v189, v11 offset:25600
    ds_read_b32 v190, v11 offset:26624
    ds_read_b32 v191, v11 offset:27648
    ds_read_b32 v192, v11 offset:28672
    ds_read_b32 v193, v11 offset:29696
    ds_read_b32 v194, v11 offset:30720
    ds_read_b32 v195, v11 offset:31744
    ds_read_b32 v196, v11 offset:32768
    ds_read_b32 v197, v11 offset:33792
    ds_read_b32 v198, v11 offset:34816
    ds_read_b32 v199, v11 offset:35840
    s_waitcnt lgkmcnt(0)
    v_add_f32 v128, v128, v129
    v_add_f32 v128, v128, v130
    v_add_f32 v128, v128, v131
    v_add_f32 v128, v128, v132
    v_add_f32 v128, v128, v133
    v_add_f32 v128, v128, v134
    v_add_f32 v128, v128, v135
    v_add_f32 v128, v128, v136
    v_add_f32 v128, v128, v137
    v_add_f32 v128, v128, v138
    v_add_f32 v128, v128, v139
    v_add_f32 v128, v128, v140
    v_add_f32 v128, v128, v141
    v_add_f32 v128, v128, v142
    v_add_f32 v128, v128, v143
    v_add_f32 v128, v128, v144
    v_add_f32 v128, v128, v145
    v_add_f32 v128, v128, v146
    v_add_f32 v128, v128, v147
    v_add_f32 v128, v128, v148
    v_add_f32 v128, v128, v149
    v_add_f32 v128, v128, v150
    v_add_f32 v128, v128, v151
    v_add_f32 v128, v128, v152
    v_add_f32 v128, v128, v153
    v_add_f32 v128, v128, v154
    v_add_f32 v128, v128, v155
    v_add_f32 v128, v128, v156
    v_add_f32 v128, v128, v157
    v_add_f32 v128, v128, v158
    v_add_f32 v128, v128, v159
    v_add_f32 v128, v128, v160
    v_add_f32 v128, v128, v161
    v_add_f32 v128, v128, v162
    v_add_f32 v128, v128, v163
    v_add_f32 v128, v128, v164
    v_add_f32 v128, v128, v165
    v_add_f32 v128, v128, v166
    v_add_f32 v128, v128, v167
    v_add_f32 v128, v128, v168
    v_add_f32 v128, v128, v169
    v_add_f32 v128, v128, v170
    v_add_f32 v128, v128, v171
    v_add_f32 v128, v128, v172
    v_add_f32 v128, v128, v173
    v_add_f32 v128, v128, v174
    v_add_f32 v128, v128, v175
    v_add_f32 v128, v128, v176
    v_add_f32 v128, v128, v177
    v_add_f32 v128, v128, v178
    v_add_f32 v128, v128, v179
    v_add_f32 v128, v128, v180
    v_add_f32 v128, v128, v181
    v_add_f32 v128, v128, v182
    v_add_f32 v128, v128, v183
    v_add_f32 v128, v128, v184
    v_add_f32 v128, v128, v185
    v_add_f32 v128, v128, v186
    v_add_f32 v128, v128, v187
    v_add_f32 v128, v128, v188
    v_add_f32 v128, v128, v189
    v_add_f32 v128, v128, v190
    v_add_f32 v128, v128, v191
    v_add_f32 v128, v128, v192
    v_add_f32 v128, v128, v193
    v_add_f32 v128, v128, v194
    v_add_f32 v128, v128, v195
    v_add_f32 v128, v128, v196
    v_add_f32 v128, v128, v197
    v_add_f32 v128, v128, v198
    v_add_f32 v128, v128, v199
    ds_write_b32 v3, v128 offset:10240
k5_skip2:
    s_mov_b64 exec, s[34:35]
    s_waitcnt lgkmcnt(0)
    s_barrier
    v_cmp_gt_u32 vcc, 128, v0
    s_and_saveexec_b64 s[34:35], vcc
    s_cbranch_execz k5_skip3
    ds_read_b32 v8, v3 offset:10240
    ds_read_b32 v9, v3 offset:10752
    s_waitcnt lgkmcnt(0)
    v_mul_f32 v10, 0xbfb8aa3b, v8
    v_exp_f32 v10, v10
    s_nop 0
    v_add_f32 v10, 1.0, v10
    v_rcp_f32 v10, v10
    s_nop 0
    v_mul_f32 v8, v8, v10
    v_mul_f32 v8, v8, v9
    v_and_b32 v9, 31, v0
    v_lshrrev_b32 v10, 5, v0
    v_lshlrev_b32 v9, 4, v9
    v_lshl_add_u32 v9, v10, 2, v9
    ds_write_b32 v9, v8 offset:9216
k5_skip3:
    s_mov_b64 exec, s[34:35]
    s_waitcnt lgkmcnt(0)
    s_barrier
    v_lshlrev_b32 v4, 4, v1
    ds_read_b128 v[32:35], v4 offset:9216
    ds_read_b128 v[36:39], v4 offset:9280
    ds_read_b128 v[40:43], v4 offset:9344
    ds_read_b128 v[44:47], v4 offset:9408
    ds_read_b128 v[48:51], v4 offset:9472
    ds_read_b128 v[52:55], v4 offset:9536
    ds_read_b128 v[56:59], v4 offset:9600
    ds_read_b128 v[60:63], v4 offset:9664
    s_waitcnt lgkmcnt(0)
    s_waitcnt vmcnt(7)
    v_lshlrev_b32 v250, 16, v64
    v_and_b32 v251, 0xffff0000, v64
    v_mul_f32 v128, v32, v250
    v_mul_f32 v129, v32, v251
    v_mul_f32 v136, v33, v250
    v_mul_f32 v137, v33, v251
    v_mul_f32 v144, v34, v250
    v_mul_f32 v145, v34, v251
    v_mul_f32 v152, v35, v250
    v_mul_f32 v153, v35, v251
    v_lshlrev_b32 v250, 16, v65
    v_and_b32 v251, 0xffff0000, v65
    v_mul_f32 v130, v32, v250
    v_mul_f32 v131, v32, v251
    v_mul_f32 v138, v33, v250
    v_mul_f32 v139, v33, v251
    v_mul_f32 v146, v34, v250
    v_mul_f32 v147, v34, v251
    v_mul_f32 v154, v35, v250
    v_mul_f32 v155, v35, v251
    v_lshlrev_b32 v250, 16, v66
    v_and_b32 v251, 0xffff0000, v66
    v_mul_f32 v132, v32, v250
    v_mul_f32 v133, v32, v251
    v_mul_f32 v140, v33, v250
    v_mul_f32 v141, v33, v251
    v_mul_f32 v148, v34, v250
    v_mul_f32 v149, v34, v251
    v_mul_f32 v156, v35, v250
    v_mul_f32 v157, v35, v251
    v_lshlrev_b32 v250, 16, v67
    v_and_b32 v251, 0xffff0000, v67
    v_mul_f32 v134, v32, v250
    v_mul_f32 v135, v32, v251
    v_mul_f32 v142, v33, v250
    v_mul_f32 v143, v33, v251
    v_mul_f32 v150, v34, v250
    v_mul_f32 v151, v34, v251
    v_mul_f32 v158, v35, v250
    v_mul_f32 v159, v35, v251
    s_waitcnt vmcnt(6)
    v_lshlrev_b32 v250, 16, v68
    v_and_b32 v251, 0xffff0000, v68
    v_fmac_f32 v128, v36, v250
    v_fmac_f32 v129, v36, v251
    v_fmac_f32 v136, v37, v250
    v_fmac_f32 v137, v37, v251
    v_fmac_f32 v144, v38, v250
    v_fmac_f32 v145, v38, v251
    v_fmac_f32 v152, v39, v250
    v_fmac_f32 v153, v39, v251
    v_lshlrev_b32 v250, 16, v69
    v_and_b32 v251, 0xffff0000, v69
    v_fmac_f32 v130, v36, v250
    v_fmac_f32 v131, v36, v251
    v_fmac_f32 v138, v37, v250
    v_fmac_f32 v139, v37, v251
    v_fmac_f32 v146, v38, v250
    v_fmac_f32 v147, v38, v251
    v_fmac_f32 v154, v39, v250
    v_fmac_f32 v155, v39, v251
    v_lshlrev_b32 v250, 16, v70
    v_and_b32 v251, 0xffff0000, v70
    v_fmac_f32 v132, v36, v250
    v_fmac_f32 v133, v36, v251
    v_fmac_f32 v140, v37, v250
    v_fmac_f32 v141, v37, v251
    v_fmac_f32 v148, v38, v250
    v_fmac_f32 v149, v38, v251
    v_fmac_f32 v156, v39, v250
    v_fmac_f32 v157, v39, v251
    v_lshlrev_b32 v250, 16, v71
    v_and_b32 v251, 0xffff0000, v71
    v_fmac_f32 v134, v36, v250
    v_fmac_f32 v135, v36, v251
    v_fmac_f32 v142, v37, v250
    v_fmac_f32 v143, v37, v251
    v_fmac_f32 v150, v38, v250
    v_fmac_f32 v151, v38, v251
    v_fmac_f32 v158, v39, v250
    v_fmac_f32 v159, v39, v251
    s_waitcnt vmcnt(5)
    v_lshlrev_b32 v250, 16, v72
    v_and_b32 v251, 0xffff0000, v72
    v_fmac_f32 v128, v40, v250
    v_fmac_f32 v129, v40, v251
    v_fmac_f32 v136, v41, v250
    v_fmac_f32 v137, v41, v251
    v_fmac_f32 v144, v42, v250
    v_fmac_f32 v145, v42, v251
    v_fmac_f32 v152, v43, v250
    v_fmac_f32 v153, v43, v251
    v_lshlrev_b32 v250, 16, v73
    v_and_b32 v251, 0xffff0000, v73
    v_fmac_f32 v130, v40, v250
    v_fmac_f32 v131, v40, v251
    v_fmac_f32 v138, v41, v250
    v_fmac_f32 v139, v41, v251
    v_fmac_f32 v146, v42, v250
    v_fmac_f32 v147, v42, v251
    v_fmac_f32 v154, v43, v250
    v_fmac_f32 v155, v43, v251
    v_lshlrev_b32 v250, 16, v74
    v_and_b32 v251, 0xffff0000, v74
    v_fmac_f32 v132, v40, v250
    v_fmac_f32 v133, v40, v251
    v_fmac_f32 v140, v41, v250
    v_fmac_f32 v141, v41, v251
    v_fmac_f32 v148, v42, v250
    v_fmac_f32 v149, v42, v251
    v_fmac_f32 v156, v43, v250
    v_fmac_f32 v157, v43, v251
    v_lshlrev_b32 v250, 16, v75
    v_and_b32 v251, 0xffff0000, v75
    v_fmac_f32 v134, v40, v250
    v_fmac_f32 v135, v40, v251
    v_fmac_f32 v142, v41, v250
    v_fmac_f32 v143, v41, v251
    v_fmac_f32 v150, v42, v250
    v_fmac_f32 v151, v42, v251
    v_fmac_f32 v158, v43, v250
    v_fmac_f32 v159, v43, v251
    s_waitcnt vmcnt(4)
    v_lshlrev_b32 v250, 16, v76
    v_and_b32 v251, 0xffff0000, v76
    v_fmac_f32 v128, v44, v250
    v_fmac_f32 v129, v44, v251
    v_fmac_f32 v136, v45, v250
    v_fmac_f32 v137, v45, v251
    v_fmac_f32 v144, v46, v250
    v_fmac_f32 v145, v46, v251
    v_fmac_f32 v152, v47, v250
    v_fmac_f32 v153, v47, v251
    v_lshlrev_b32 v250, 16, v77
    v_and_b32 v251, 0xffff0000, v77
    v_fmac_f32 v130, v44, v250
    v_fmac_f32 v131, v44, v251
    v_fmac_f32 v138, v45, v250
    v_fmac_f32 v139, v45, v251
    v_fmac_f32 v146, v46, v250
    v_fmac_f32 v147, v46, v251
    v_fmac_f32 v154, v47, v250
    v_fmac_f32 v155, v47, v251
    v_lshlrev_b32 v250, 16, v78
    v_and_b32 v251, 0xffff0000, v78
    v_fmac_f32 v132, v44, v250
    v_fmac_f32 v133, v44, v251
    v_fmac_f32 v140, v45, v250
    v_fmac_f32 v141, v45, v251
    v_fmac_f32 v148, v46, v250
    v_fmac_f32 v149, v46, v251
    v_fmac_f32 v156, v47, v250
    v_fmac_f32 v157, v47, v251
    v_lshlrev_b32 v250, 16, v79
    v_and_b32 v251, 0xffff0000, v79
    v_fmac_f32 v134, v44, v250
    v_fmac_f32 v135, v44, v251
    v_fmac_f32 v142, v45, v250
    v_fmac_f32 v143, v45, v251
    v_fmac_f32 v150, v46, v250
    v_fmac_f32 v151, v46, v251
    v_fmac_f32 v158, v47, v250
    v_fmac_f32 v159, v47, v251
    s_waitcnt vmcnt(3)
    v_lshlrev_b32 v250, 16, v80
    v_and_b32 v251, 0xffff0000, v80
    v_fmac_f32 v128, v48, v250
    v_fmac_f32 v129, v48, v251
    v_fmac_f32 v136, v49, v250
    v_fmac_f32 v137, v49, v251
    v_fmac_f32 v144, v50, v250
    v_fmac_f32 v145, v50, v251
    v_fmac_f32 v152, v51, v250
    v_fmac_f32 v153, v51, v251
    v_lshlrev_b32 v250, 16, v81
    v_and_b32 v251, 0xffff0000, v81
    v_fmac_f32 v130, v48, v250
    v_fmac_f32 v131, v48, v251
    v_fmac_f32 v138, v49, v250
    v_fmac_f32 v139, v49, v251
    v_fmac_f32 v146, v50, v250
    v_fmac_f32 v147, v50, v251
    v_fmac_f32 v154, v51, v250
    v_fmac_f32 v155, v51, v251
    v_lshlrev_b32 v250, 16, v82
    v_and_b32 v251, 0xffff0000, v82
    v_fmac_f32 v132, v48, v250
    v_fmac_f32 v133, v48, v251
    v_fmac_f32 v140, v49, v250
    v_fmac_f32 v141, v49, v251
    v_fmac_f32 v148, v50, v250
    v_fmac_f32 v149, v50, v251
    v_fmac_f32 v156, v51, v250
    v_fmac_f32 v157, v51, v251
    v_lshlrev_b32 v250, 16, v83
    v_and_b32 v251, 0xffff0000, v83
    v_fmac_f32 v134, v48, v250
    v_fmac_f32 v135, v48, v251
    v_fmac_f32 v142, v49, v250
    v_fmac_f32 v143, v49, v251
    v_fmac_f32 v150, v50, v250
    v_fmac_f32 v151, v50, v251
    v_fmac_f32 v158, v51, v250
    v_fmac_f32 v159, v51, v251
    s_waitcnt vmcnt(2)
    v_lshlrev_b32 v250, 16, v84
    v_and_b32 v251, 0xffff0000, v84
    v_fmac_f32 v128, v52, v250
    v_fmac_f32 v129, v52, v251
    v_fmac_f32 v136, v53, v250
    v_fmac_f32 v137, v53, v251
    v_fmac_f32 v144, v54, v250
    v_fmac_f32 v145, v54, v251
    v_fmac_f32 v152, v55, v250
    v_fmac_f32 v153, v55, v251
    v_lshlrev_b32 v250, 16, v85
    v_and_b32 v251, 0xffff0000, v85
    v_fmac_f32 v130, v52, v250
    v_fmac_f32 v131, v52, v251
    v_fmac_f32 v138, v53, v250
    v_fmac_f32 v139, v53, v251
    v_fmac_f32 v146, v54, v250
    v_fmac_f32 v147, v54, v251
    v_fmac_f32 v154, v55, v250
    v_fmac_f32 v155, v55, v251
    v_lshlrev_b32 v250, 16, v86
    v_and_b32 v251, 0xffff0000, v86
    v_fmac_f32 v132, v52, v250
    v_fmac_f32 v133, v52, v251
    v_fmac_f32 v140, v53, v250
    v_fmac_f32 v141, v53, v251
    v_fmac_f32 v148, v54, v250
    v_fmac_f32 v149, v54, v251
    v_fmac_f32 v156, v55, v250
    v_fmac_f32 v157, v55, v251
    v_lshlrev_b32 v250, 16, v87
    v_and_b32 v251, 0xffff0000, v87
    v_fmac_f32 v134, v52, v250
    v_fmac_f32 v135, v52, v251
    v_fmac_f32 v142, v53, v250
    v_fmac_f32 v143, v53, v251
    v_fmac_f32 v150, v54, v250
    v_fmac_f32 v151, v54, v251
    v_fmac_f32 v158, v55, v250
    v_fmac_f32 v159, v55, v251
    s_waitcnt vmcnt(1)
    v_lshlrev_b32 v250, 16, v88
    v_and_b32 v251, 0xffff0000, v88
    v_fmac_f32 v128, v56, v250
    v_fmac_f32 v129, v56, v251
    v_fmac_f32 v136, v57, v250
    v_fmac_f32 v137, v57, v251
    v_fmac_f32 v144, v58, v250
    v_fmac_f32 v145, v58, v251
    v_fmac_f32 v152, v59, v250
    v_fmac_f32 v153, v59, v251
    v_lshlrev_b32 v250, 16, v89
    v_and_b32 v251, 0xffff0000, v89
    v_fmac_f32 v130, v56, v250
    v_fmac_f32 v131, v56, v251
    v_fmac_f32 v138, v57, v250
    v_fmac_f32 v139, v57, v251
    v_fmac_f32 v146, v58, v250
    v_fmac_f32 v147, v58, v251
    v_fmac_f32 v154, v59, v250
    v_fmac_f32 v155, v59, v251
    v_lshlrev_b32 v250, 16, v90
    v_and_b32 v251, 0xffff0000, v90
    v_fmac_f32 v132, v56, v250
    v_fmac_f32 v133, v56, v251
    v_fmac_f32 v140, v57, v250
    v_fmac_f32 v141, v57, v251
    v_fmac_f32 v148, v58, v250
    v_fmac_f32 v149, v58, v251
    v_fmac_f32 v156, v59, v250
    v_fmac_f32 v157, v59, v251
    v_lshlrev_b32 v250, 16, v91
    v_and_b32 v251, 0xffff0000, v91
    v_fmac_f32 v134, v56, v250
    v_fmac_f32 v135, v56, v251
    v_fmac_f32 v142, v57, v250
    v_fmac_f32 v143, v57, v251
    v_fmac_f32 v150, v58, v250
    v_fmac_f32 v151, v58, v251
    v_fmac_f32 v158, v59, v250
    v_fmac_f32 v159, v59, v251
    s_waitcnt vmcnt(0)
    v_lshlrev_b32 v250, 16, v92
    v_and_b32 v251, 0xffff0000, v92
    v_fmac_f32 v128, v60, v250
    v_fmac_f32 v129, v60, v251
    v_fmac_f32 v136, v61, v250
    v_fmac_f32 v137, v61, v251
    v_fmac_f32 v144, v62, v250
    v_fmac_f32 v145, v62, v251
    v_fmac_f32 v152, v63, v250
    v_fmac_f32 v153, v63, v251
    v_lshlrev_b32 v250, 16, v93
    v_and_b32 v251, 0xffff0000, v93
    v_fmac_f32 v130, v60, v250
    v_fmac_f32 v131, v60, v251
    v_fmac_f32 v138, v61, v250
    v_fmac_f32 v139, v61, v251
    v_fmac_f32 v146, v62, v250
    v_fmac_f32 v147, v62, v251
    v_fmac_f32 v154, v63, v250
    v_fmac_f32 v155, v63, v251
    v_lshlrev_b32 v250, 16, v94
    v_and_b32 v251, 0xffff0000, v94
    v_fmac_f32 v132, v60, v250
    v_fmac_f32 v133, v60, v251
    v_fmac_f32 v140, v61, v250
    v_fmac_f32 v141, v61, v251
    v_fmac_f32 v148, v62, v250
    v_fmac_f32 v149, v62, v251
    v_fmac_f32 v156, v63, v250
    v_fmac_f32 v157, v63, v251
    v_lshlrev_b32 v250, 16, v95
    v_and_b32 v251, 0xffff0000, v95
    v_fmac_f32 v134, v60, v250
    v_fmac_f32 v135, v60, v251
    v_fmac_f32 v142, v61, v250
    v_fmac_f32 v143, v61, v251
    v_fmac_f32 v150, v62, v250
    v_fmac_f32 v151, v62, v251
    v_fmac_f32 v158, v63, v250
    v_fmac_f32 v159, v63, v251
    v_mul_u32_u24 v3, 9216, v1
    v_lshl_add_u32 v3, v2, 5, v3
    ds_write_b128 v3, v[128:131] offset:12288
    ds_write_b128 v3, v[132:135] offset:12304
    ds_write_b128 v3, v[136:139] offset:14592
    ds_write_b128 v3, v[140:143] offset:14608
    ds_write_b128 v3, v[144:147] offset:16896
    ds_write_b128 v3, v[148:151] offset:16912
    ds_write_b128 v3, v[152:155] offset:19200
    ds_write_b128 v3, v[156:159] offset:19216
    s_waitcnt lgkmcnt(0)
    s_barrier
    v_mul_u32_u24 v3, 2304, v1
    v_lshl_add_u32 v3, v2, 5, v3
    ds_read_b128 v[128:131], v3 offset:12288
    ds_read_b128 v[132:135], v3 offset:12304
    ds_read_b128 v[136:139], v3 offset:21504
    ds_read_b128 v[140:143], v3 offset:21520
    ds_read_b128 v[144:147], v3 offset:30720
    ds_read_b128 v[148:151], v3 offset:30736
    ds_read_b128 v[152:155], v3 offset:39936
    ds_read_b128 v[156:159], v3 offset:39952
    s_waitcnt lgkmcnt(0)
    v_add_f32 v128, v128, v136
    v_add_f32 v129, v129, v137
    v_add_f32 v130, v130, v138
    v_add_f32 v131, v131, v139
    v_add_f32 v132, v132, v140
    v_add_f32 v133, v133, v141
    v_add_f32 v134, v134, v142
    v_add_f32 v135, v135, v143
    v_add_f32 v128, v128, v144
    v_add_f32 v129, v129, v145
    v_add_f32 v130, v130, v146
    v_add_f32 v131, v131, v147
    v_add_f32 v132, v132, v148
    v_add_f32 v133, v133, v149
    v_add_f32 v134, v134, v150
    v_add_f32 v135, v135, v151
    v_add_f32 v128, v128, v152
    v_add_f32 v129, v129, v153
    v_add_f32 v130, v130, v154
    v_add_f32 v131, v131, v155
    v_add_f32 v132, v132, v156
    v_add_f32 v133, v133, v157
    v_add_f32 v134, v134, v158
    v_add_f32 v135, v135, v159
    s_mul_i32 s29, s2, 9216
    s_add_u32 s29, s29, 2097152
    s_add_u32 s30, s8, s29
    s_addc_u32 s31, s9, 0
    global_store_dwordx4 v3, v[128:131], s[30:31]
    global_store_dwordx4 v3, v[132:135], s[30:31] offset:16
k5_end:
    s_endpgm
.globl k6_fin_kernel
.p2align 8
.type k6_fin_kernel,@function
k6_fin_kernel:
    s_load_dwordx2 s[4:5], s[0:1], 0
    s_load_dwordx2 s[6:7], s[0:1], 88
    s_load_dwordx2 s[8:9], s[0:1], 104
    s_cmp_ge_u32 s2, 8
    s_cbranch_scc1 k6_end
    s_waitcnt lgkmcnt(0)
    s_mul_i32 s20, s2, 288
    v_add_u32 v1, s20, v0
    v_lshlrev_b32 v2, 1, v1
    global_load_ushort v8, v2, s[4:5]
    v_lshlrev_b32 v3, 2, v1
    s_add_u32 s30, s8, 1114112
    s_addc_u32 s31, s9, 0
    global_load_dword v9, v3, s[30:31]
    global_load_dword v10, v3, s[30:31] offset:0
    s_add_u32 s30, s8, 2097152
    s_addc_u32 s31, s9, 0
    global_load_dword v32, v3, s[30:31]
    s_add_u32 s30, s30, 9216
    s_addc_u32 s31, s31, 0
    global_load_dword v33, v3, s[30:31]
    s_add_u32 s30, s30, 9216
    s_addc_u32 s31, s31, 0
    global_load_dword v34, v3, s[30:31]
    s_add_u32 s30, s30, 9216
    s_addc_u32 s31, s31, 0
    global_load_dword v35, v3, s[30:31]
    s_add_u32 s30, s30, 9216
    s_addc_u32 s31, s31, 0
    global_load_dword v36, v3, s[30:31]
    s_add_u32 s30, s30, 9216
    s_addc_u32 s31, s31, 0
    global_load_dword v37, v3, s[30:31]
    s_add_u32 s30, s30, 9216
    s_addc_u32 s31, s31, 0
    global_load_dword v38, v3, s[30:31]
    s_add_u32 s30, s30, 9216
    s_addc_u32 s31, s31, 0
    global_load_dword v39, v3, s[30:31]
    s_add_u32 s30, s30, 9216
    s_addc_u32 s31, s31, 0
    global_load_dword v40, v3, s[30:31]
    s_add_u32 s30, s30, 9216
    s_addc_u32 s31, s31, 0
    global_load_dword v41, v3, s[30:31]
    s_add_u32 s30, s30, 9216
    s_addc_u32 s31, s31, 0
    global_load_dword v42, v3, s[30:31]
    s_add_u32 s30, s30, 9216
    s_addc_u32 s31, s31, 0
    global_load_dword v43, v3, s[30:31]
    s_add_u32 s30, s30, 9216
    s_addc_u32 s31, s31, 0
    global_load_dword v44, v3, s[30:31]
    s_add_u32 s30, s30, 9216
    s_addc_u32 s31, s31, 0
    global_load_dword v45, v3, s[30:31]
    s_add_u32 s30, s30, 9216
    s_addc_u32 s31, s31, 0
    global_load_dword v46, v3, s[30:31]
    s_add_u32 s30, s30, 9216
    s_addc_u32 s31, s31, 0
    global_load_dword v47, v3, s[30:31]
    s_add_u32 s30, s30, 9216
    s_addc_u32 s31, s31, 0
    global_load_dword v48, v3, s[30:31]
    s_add_u32 s30, s30, 9216
    s_addc_u32 s31, s31, 0
    global_load_dword v49, v3, s[30:31]
    s_add_u32 s30, s30, 9216
    s_addc_u32 s31, s31, 0
    global_load_dword v50, v3, s[30:31]
    s_add_u32 s30, s30, 9216
    s_addc_u32 s31, s31, 0
    global_load_dword v51, v3, s[30:31]
    s_add_u32 s30, s30, 9216
    s_addc_u32 s31, s31, 0
    global_load_dword v52, v3, s[30:31]
    s_add_u32 s30, s30, 9216
    s_addc_u32 s31, s31, 0
    global_load_dword v53, v3, s[30:31]
    s_add_u32 s30, s30, 9216
    s_addc_u32 s31, s31, 0
    global_load_dword v54, v3, s[30:31]
    s_add_u32 s30, s30, 9216
    s_addc_u32 s31, s31, 0
    global_load_dword v55, v3, s[30:31]
    s_add_u32 s30, s30, 9216
    s_addc_u32 s31, s31, 0
    global_load_dword v56, v3, s[30:31]
    s_add_u32 s30, s30, 9216
    s_addc_u32 s31, s31, 0
    global_load_dword v57, v3, s[30:31]
    s_add_u32 s30, s30, 9216
    s_addc_u32 s31, s31, 0
    global_load_dword v58, v3, s[30:31]
    s_add_u32 s30, s30, 9216
    s_addc_u32 s31, s31, 0
    global_load_dword v59, v3, s[30:31]
    s_add_u32 s30, s30, 9216
    s_addc_u32 s31, s31, 0
    global_load_dword v60, v3, s[30:31]
    s_add_u32 s30, s30, 9216
    s_addc_u32 s31, s31, 0
    global_load_dword v61, v3, s[30:31]
    s_add_u32 s30, s30, 9216
    s_addc_u32 s31, s31, 0
    global_load_dword v62, v3, s[30:31]
    s_add_u32 s30, s30, 9216
    s_addc_u32 s31, s31, 0
    global_load_dword v63, v3, s[30:31]
    s_add_u32 s30, s30, 9216
    s_addc_u32 s31, s31, 0
    global_load_dword v64, v3, s[30:31]
    s_add_u32 s30, s30, 9216
    s_addc_u32 s31, s31, 0
    global_load_dword v65, v3, s[30:31]
    s_add_u32 s30, s30, 9216
    s_addc_u32 s31, s31, 0
    global_load_dword v66, v3, s[30:31]
    s_add_u32 s30, s30, 9216
    s_addc_u32 s31, s31, 0
    global_load_dword v67, v3, s[30:31]
    s_add_u32 s30, s30, 9216
    s_addc_u32 s31, s31, 0
    global_load_dword v68, v3, s[30:31]
    s_add_u32 s30, s30, 9216
    s_addc_u32 s31, s31, 0
    global_load_dword v69, v3, s[30:31]
    s_add_u32 s30, s30, 9216
    s_addc_u32 s31, s31, 0
    global_load_dword v70, v3, s[30:31]
    s_add_u32 s30, s30, 9216
    s_addc_u32 s31, s31, 0
    global_load_dword v71, v3, s[30:31]
    s_add_u32 s30, s30, 9216
    s_addc_u32 s31, s31, 0
    global_load_dword v72, v3, s[30:31]
    s_add_u32 s30, s30, 9216
    s_addc_u32 s31, s31, 0
    global_load_dword v73, v3, s[30:31]
    s_add_u32 s30, s30, 9216
    s_addc_u32 s31, s31, 0
    global_load_dword v74, v3, s[30:31]
    s_add_u32 s30, s30, 9216
    s_addc_u32 s31, s31, 0
    global_load_dword v75, v3, s[30:31]
    s_add_u32 s30, s30, 9216
    s_addc_u32 s31, s31, 0
    global_load_dword v76, v3, s[30:31]
    s_add_u32 s30, s30, 9216
    s_addc_u32 s31, s31, 0
    global_load_dword v77, v3, s[30:31]
    s_add_u32 s30, s30, 9216
    s_addc_u32 s31, s31, 0
    global_load_dword v78, v3, s[30:31]
    s_add_u32 s30, s30, 9216
    s_addc_u32 s31, s31, 0
    global_load_dword v79, v3, s[30:31]
    s_add_u32 s30, s30, 9216
    s_addc_u32 s31, s31, 0
    global_load_dword v80, v3, s[30:31]
    s_add_u32 s30, s30, 9216
    s_addc_u32 s31, s31, 0
    global_load_dword v81, v3, s[30:31]
    s_add_u32 s30, s30, 9216
    s_addc_u32 s31, s31, 0
    global_load_dword v82, v3, s[30:31]
    s_add_u32 s30, s30, 9216
    s_addc_u32 s31, s31, 0
    global_load_dword v83, v3, s[30:31]
    s_add_u32 s30, s30, 9216
    s_addc_u32 s31, s31, 0
    global_load_dword v84, v3, s[30:31]
    s_add_u32 s30, s30, 9216
    s_addc_u32 s31, s31, 0
    global_load_dword v85, v3, s[30:31]
    s_add_u32 s30, s30, 9216
    s_addc_u32 s31, s31, 0
    global_load_dword v86, v3, s[30:31]
    s_add_u32 s30, s30, 9216
    s_addc_u32 s31, s31, 0
    global_load_dword v87, v3, s[30:31]
    s_add_u32 s30, s30, 9216
    s_addc_u32 s31, s31, 0
    global_load_dword v88, v3, s[30:31]
    s_add_u32 s30, s30, 9216
    s_addc_u32 s31, s31, 0
    global_load_dword v89, v3, s[30:31]
    s_add_u32 s30, s30, 9216
    s_addc_u32 s31, s31, 0
    global_load_dword v90, v3, s[30:31]
    s_add_u32 s30, s30, 9216
    s_addc_u32 s31, s31, 0
    global_load_dword v91, v3, s[30:31]
    s_add_u32 s30, s30, 9216
    s_addc_u32 s31, s31, 0
    global_load_dword v92, v3, s[30:31]
    s_add_u32 s30, s30, 9216
    s_addc_u32 s31, s31, 0
    global_load_dword v93, v3, s[30:31]
    s_add_u32 s30, s30, 9216
    s_addc_u32 s31, s31, 0
    global_load_dword v94, v3, s[30:31]
    s_add_u32 s30, s30, 9216
    s_addc_u32 s31, s31, 0
    global_load_dword v95, v3, s[30:31]
    s_add_u32 s30, s30, 9216
    s_addc_u32 s31, s31, 0
    global_load_dword v96, v3, s[30:31]
    s_add_u32 s30, s30, 9216
    s_addc_u32 s31, s31, 0
    global_load_dword v97, v3, s[30:31]
    s_add_u32 s30, s30, 9216
    s_addc_u32 s31, s31, 0
    global_load_dword v98, v3, s[30:31]
    s_add_u32 s30, s30, 9216
    s_addc_u32 s31, s31, 0
    global_load_dword v99, v3, s[30:31]
    s_add_u32 s30, s30, 9216
    s_addc_u32 s31, s31, 0
    global_load_dword v100, v3, s[30:31]
    s_add_u32 s30, s30, 9216
    s_addc_u32 s31, s31, 0
    global_load_dword v101, v3, s[30:31]
    s_add_u32 s30, s30, 9216
    s_addc_u32 s31, s31, 0
    global_load_dword v102, v3, s[30:31]
    s_add_u32 s30, s30, 9216
    s_addc_u32 s31, s31, 0
    global_load_dword v103, v3, s[30:31]
    s_add_u32 s30, s30, 9216
    s_addc_u32 s31, s31, 0
    global_load_dword v104, v3, s[30:31]
    s_add_u32 s30, s30, 9216
    s_addc_u32 s31, s31, 0
    global_load_dword v105, v3, s[30:31]
    s_add_u32 s30, s30, 9216
    s_addc_u32 s31, s31, 0
    global_load_dword v106, v3, s[30:31]
    s_add_u32 s30, s30, 9216
    s_addc_u32 s31, s31, 0
    global_load_dword v107, v3, s[30:31]
    s_add_u32 s30, s30, 9216
    s_addc_u32 s31, s31, 0
    global_load_dword v108, v3, s[30:31]
    s_add_u32 s30, s30, 9216
    s_addc_u32 s31, s31, 0
    global_load_dword v109, v3, s[30:31]
    s_add_u32 s30, s30, 9216
    s_addc_u32 s31, s31, 0
    global_load_dword v110, v3, s[30:31]
    s_add_u32 s30, s30, 9216
    s_addc_u32 s31, s31, 0
    global_load_dword v111, v3, s[30:31]
    s_add_u32 s30, s30, 9216
    s_addc_u32 s31, s31, 0
    global_load_dword v112, v3, s[30:31]
    s_add_u32 s30, s30, 9216
    s_addc_u32 s31, s31, 0
    global_load_dword v113, v3, s[30:31]
    s_add_u32 s30, s30, 9216
    s_addc_u32 s31, s31, 0
    global_load_dword v114, v3, s[30:31]
    s_add_u32 s30, s30, 9216
    s_addc_u32 s31, s31, 0
    global_load_dword v115, v3, s[30:31]
    s_add_u32 s30, s30, 9216
    s_addc_u32 s31, s31, 0
    global_load_dword v116, v3, s[30:31]
    s_add_u32 s30, s30, 9216
    s_addc_u32 s31, s31, 0
    global_load_dword v117, v3, s[30:31]
    s_add_u32 s30, s30, 9216
    s_addc_u32 s31, s31, 0
    global_load_dword v118, v3, s[30:31]
    s_add_u32 s30, s30, 9216
    s_addc_u32 s31, s31, 0
    global_load_dword v119, v3, s[30:31]
    s_add_u32 s30, s30, 9216
    s_addc_u32 s31, s31, 0
    global_load_dword v120, v3, s[30:31]
    s_add_u32 s30, s30, 9216
    s_addc_u32 s31, s31, 0
    global_load_dword v121, v3, s[30:31]
    s_add_u32 s30, s30, 9216
    s_addc_u32 s31, s31, 0
    global_load_dword v122, v3, s[30:31]
    s_add_u32 s30, s30, 9216
    s_addc_u32 s31, s31, 0
    global_load_dword v123, v3, s[30:31]
    s_add_u32 s30, s30, 9216
    s_addc_u32 s31, s31, 0
    global_load_dword v124, v3, s[30:31]
    s_add_u32 s30, s30, 9216
    s_addc_u32 s31, s31, 0
    global_load_dword v125, v3, s[30:31]
    s_add_u32 s30, s30, 9216
    s_addc_u32 s31, s31, 0
    global_load_dword v126, v3, s[30:31]
    s_add_u32 s30, s30, 9216
    s_addc_u32 s31, s31, 0
    global_load_dword v127, v3, s[30:31]
    s_add_u32 s30, s30, 9216
    s_addc_u32 s31, s31, 0
    global_load_dword v128, v3, s[30:31]
    s_add_u32 s30, s30, 9216
    s_addc_u32 s31, s31, 0
    global_load_dword v129, v3, s[30:31]
    s_add_u32 s30, s30, 9216
    s_addc_u32 s31, s31, 0
    global_load_dword v130, v3, s[30:31]
    s_add_u32 s30, s30, 9216
    s_addc_u32 s31, s31, 0
    global_load_dword v131, v3, s[30:31]
    s_add_u32 s30, s30, 9216
    s_addc_u32 s31, s31, 0
    global_load_dword v132, v3, s[30:31]
    s_add_u32 s30, s30, 9216
    s_addc_u32 s31, s31, 0
    global_load_dword v133, v3, s[30:31]
    s_add_u32 s30, s30, 9216
    s_addc_u32 s31, s31, 0
    global_load_dword v134, v3, s[30:31]
    s_add_u32 s30, s30, 9216
    s_addc_u32 s31, s31, 0
    global_load_dword v135, v3, s[30:31]
    s_add_u32 s30, s30, 9216
    s_addc_u32 s31, s31, 0
    global_load_dword v136, v3, s[30:31]
    s_add_u32 s30, s30, 9216
    s_addc_u32 s31, s31, 0
    global_load_dword v137, v3, s[30:31]
    s_add_u32 s30, s30, 9216
    s_addc_u32 s31, s31, 0
    global_load_dword v138, v3, s[30:31]
    s_add_u32 s30, s30, 9216
    s_addc_u32 s31, s31, 0
    global_load_dword v139, v3, s[30:31]
    s_add_u32 s30, s30, 9216
    s_addc_u32 s31, s31, 0
    global_load_dword v140, v3, s[30:31]
    s_add_u32 s30, s30, 9216
    s_addc_u32 s31, s31, 0
    global_load_dword v141, v3, s[30:31]
    s_add_u32 s30, s30, 9216
    s_addc_u32 s31, s31, 0
    global_load_dword v142, v3, s[30:31]
    s_add_u32 s30, s30, 9216
    s_addc_u32 s31, s31, 0
    global_load_dword v143, v3, s[30:31]
    s_add_u32 s30, s30, 9216
    s_addc_u32 s31, s31, 0
    global_load_dword v144, v3, s[30:31]
    s_add_u32 s30, s30, 9216
    s_addc_u32 s31, s31, 0
    global_load_dword v145, v3, s[30:31]
    s_add_u32 s30, s30, 9216
    s_addc_u32 s31, s31, 0
    global_load_dword v146, v3, s[30:31]
    s_add_u32 s30, s30, 9216
    s_addc_u32 s31, s31, 0
    global_load_dword v147, v3, s[30:31]
    s_add_u32 s30, s30, 9216
    s_addc_u32 s31, s31, 0
    global_load_dword v148, v3, s[30:31]
    s_add_u32 s30, s30, 9216
    s_addc_u32 s31, s31, 0
    global_load_dword v149, v3, s[30:31]
    s_add_u32 s30, s30, 9216
    s_addc_u32 s31, s31, 0
    global_load_dword v150, v3, s[30:31]
    s_add_u32 s30, s30, 9216
    s_addc_u32 s31, s31, 0
    global_load_dword v151, v3, s[30:31]
    s_add_u32 s30, s30, 9216
    s_addc_u32 s31, s31, 0
    global_load_dword v152, v3, s[30:31]
    s_add_u32 s30, s30, 9216
    s_addc_u32 s31, s31, 0
    global_load_dword v153, v3, s[30:31]
    s_add_u32 s30, s30, 9216
    s_addc_u32 s31, s31, 0
    global_load_dword v154, v3, s[30:31]
    s_add_u32 s30, s30, 9216
    s_addc_u32 s31, s31, 0
    global_load_dword v155, v3, s[30:31]
    s_add_u32 s30, s30, 9216
    s_addc_u32 s31, s31, 0
    global_load_dword v156, v3, s[30:31]
    s_add_u32 s30, s30, 9216
    s_addc_u32 s31, s31, 0
    global_load_dword v157, v3, s[30:31]
    s_add_u32 s30, s30, 9216
    s_addc_u32 s31, s31, 0
    global_load_dword v158, v3, s[30:31]
    s_add_u32 s30, s30, 9216
    s_addc_u32 s31, s31, 0
    global_load_dword v159, v3, s[30:31]
    s_add_u32 s30, s30, 9216
    s_addc_u32 s31, s31, 0
    global_load_dword v160, v3, s[30:31]
    s_add_u32 s30, s30, 9216
    s_addc_u32 s31, s31, 0
    global_load_dword v161, v3, s[30:31]
    s_add_u32 s30, s30, 9216
    s_addc_u32 s31, s31, 0
    global_load_dword v162, v3, s[30:31]
    s_add_u32 s30, s30, 9216
    s_addc_u32 s31, s31, 0
    global_load_dword v163, v3, s[30:31]
    s_add_u32 s30, s30, 9216
    s_addc_u32 s31, s31, 0
    global_load_dword v164, v3, s[30:31]
    s_add_u32 s30, s30, 9216
    s_addc_u32 s31, s31, 0
    global_load_dword v165, v3, s[30:31]
    s_add_u32 s30, s30, 9216
    s_addc_u32 s31, s31, 0
    global_load_dword v166, v3, s[30:31]
    s_add_u32 s30, s30, 9216
    s_addc_u32 s31, s31, 0
    global_load_dword v167, v3, s[30:31]
    s_add_u32 s30, s30, 9216
    s_addc_u32 s31, s31, 0
    global_load_dword v168, v3, s[30:31]
    s_add_u32 s30, s30, 9216
    s_addc_u32 s31, s31, 0
    global_load_dword v169, v3, s[30:31]
    s_add_u32 s30, s30, 9216
    s_addc_u32 s31, s31, 0
    global_load_dword v170, v3, s[30:31]
    s_add_u32 s30, s30, 9216
    s_addc_u32 s31, s31, 0
    global_load_dword v171, v3, s[30:31]
    s_add_u32 s30, s30, 9216
    s_addc_u32 s31, s31, 0
    global_load_dword v172, v3, s[30:31]
    s_add_u32 s30, s30, 9216
    s_addc_u32 s31, s31, 0
    global_load_dword v173, v3, s[30:31]
    s_add_u32 s30, s30, 9216
    s_addc_u32 s31, s31, 0
    global_load_dword v174, v3, s[30:31]
    s_add_u32 s30, s30, 9216
    s_addc_u32 s31, s31, 0
    global_load_dword v175, v3, s[30:31]
    s_add_u32 s30, s30, 9216
    s_addc_u32 s31, s31, 0
    s_lshr_b32 s21, s2, 1
    s_mul_i32 s20, s21, 3456
    s_and_b32 s21, s2, 1
    s_mul_i32 s21, s21, 288
    s_add_u32 s20, s20, s21
    v_add_u32 v4, s20, v0
    v_lshlrev_b32 v4, 2, v4
    s_add_u32 s30, s8, 4608
    s_addc_u32 s31, s9, 0
    global_load_dword v16, v4, s[30:31]
    s_add_u32 s30, s8, 11520
    s_addc_u32 s31, s9, 0
    global_load_dword v20, v4, s[30:31]
    s_add_u32 s30, s8, 59904
    s_addc_u32 s31, s9, 0
    global_load_dword v17, v4, s[30:31]
    s_add_u32 s30, s8, 66816
    s_addc_u32 s31, s9, 0
    global_load_dword v21, v4, s[30:31]
    s_add_u32 s30, s8, 115200
    s_addc_u32 s31, s9, 0
    global_load_dword v18, v4, s[30:31]
    s_add_u32 s30, s8, 122112
    s_addc_u32 s31, s9, 0
    global_load_dword v22, v4, s[30:31]
    s_add_u32 s30, s8, 170496
    s_addc_u32 s31, s9, 0
    global_load_dword v19, v4, s[30:31]
    s_add_u32 s30, s8, 177408
    s_addc_u32 s31, s9, 0
    global_load_dword v23, v4, s[30:31]
    s_waitcnt vmcnt(0)
    v_add_f32 v16, v16, v17
    v_add_f32 v16, v16, v18
    v_add_f32 v16, v16, v19
    v_add_f32 v20, v20, v21
    v_add_f32 v20, v20, v22
    v_add_f32 v20, v20, v23
    v_mov_b32 v10, v32
    v_add_f32 v10, v10, v33
    v_add_f32 v10, v10, v34
    v_add_f32 v10, v10, v35
    v_add_f32 v10, v10, v36
    v_add_f32 v10, v10, v37
    v_add_f32 v10, v10, v38
    v_add_f32 v10, v10, v39
    v_add_f32 v10, v10, v40
    v_add_f32 v10, v10, v41
    v_add_f32 v10, v10, v42
    v_add_f32 v10, v10, v43
    v_add_f32 v10, v10, v44
    v_add_f32 v10, v10, v45
    v_add_f32 v10, v10, v46
    v_add_f32 v10, v10, v47
    v_add_f32 v10, v10, v48
    v_add_f32 v10, v10, v49
    v_add_f32 v10, v10, v50
    v_add_f32 v10, v10, v51
    v_add_f32 v10, v10, v52
    v_add_f32 v10, v10, v53
    v_add_f32 v10, v10, v54
    v_add_f32 v10, v10, v55
    v_add_f32 v10, v10, v56
    v_add_f32 v10, v10, v57
    v_add_f32 v10, v10, v58
    v_add_f32 v10, v10, v59
    v_add_f32 v10, v10, v60
    v_add_f32 v10, v10, v61
    v_add_f32 v10, v10, v62
    v_add_f32 v10, v10, v63
    v_add_f32 v10, v10, v64
    v_add_f32 v10, v10, v65
    v_add_f32 v10, v10, v66
    v_add_f32 v10, v10, v67
    v_add_f32 v10, v10, v68
    v_add_f32 v10, v10, v69
    v_add_f32 v10, v10, v70
    v_add_f32 v10, v10, v71
    v_add_f32 v10, v10, v72
    v_add_f32 v10, v10, v73
    v_add_f32 v10, v10, v74
    v_add_f32 v10, v10, v75
    v_add_f32 v10, v10, v76
    v_add_f32 v10, v10, v77
    v_add_f32 v10, v10, v78
    v_add_f32 v10, v10, v79
    v_add_f32 v10, v10, v80
    v_add_f32 v10, v10, v81
    v_add_f32 v10, v10, v82
    v_add_f32 v10, v10, v83
    v_add_f32 v10, v10, v84
    v_add_f32 v10, v10, v85
    v_add_f32 v10, v10, v86
    v_add_f32 v10, v10, v87
    v_add_f32 v10, v10, v88
    v_add_f32 v10, v10, v89
    v_add_f32 v10, v10, v90
    v_add_f32 v10, v10, v91
    v_add_f32 v10, v10, v92
    v_add_f32 v10, v10, v93
    v_add_f32 v10, v10, v94
    v_add_f32 v10, v10, v95
    v_add_f32 v10, v10, v96
    v_add_f32 v10, v10, v97
    v_add_f32 v10, v10, v98
    v_add_f32 v10, v10, v99
    v_add_f32 v10, v10, v100
    v_add_f32 v10, v10, v101
    v_add_f32 v10, v10, v102
    v_add_f32 v10, v10, v103
    v_add_f32 v10, v10, v104
    v_add_f32 v10, v10, v105
    v_add_f32 v10, v10, v106
    v_add_f32 v10, v10, v107
    v_add_f32 v10, v10, v108
    v_add_f32 v10, v10, v109
    v_add_f32 v10, v10, v110
    v_add_f32 v10, v10, v111
    v_add_f32 v10, v10, v112
    v_add_f32 v10, v10, v113
    v_add_f32 v10, v10, v114
    v_add_f32 v10, v10, v115
    v_add_f32 v10, v10, v116
    v_add_f32 v10, v10, v117
    v_add_f32 v10, v10, v118
    v_add_f32 v10, v10, v119
    v_add_f32 v10, v10, v120
    v_add_f32 v10, v10, v121
    v_add_f32 v10, v10, v122
    v_add_f32 v10, v10, v123
    v_add_f32 v10, v10, v124
    v_add_f32 v10, v10, v125
    v_add_f32 v10, v10, v126
    v_add_f32 v10, v10, v127
    v_add_f32 v10, v10, v128
    v_add_f32 v10, v10, v129
    v_add_f32 v10, v10, v130
    v_add_f32 v10, v10, v131
    v_add_f32 v10, v10, v132
    v_add_f32 v10, v10, v133
    v_add_f32 v10, v10, v134
    v_add_f32 v10, v10, v135
    v_add_f32 v10, v10, v136
    v_add_f32 v10, v10, v137
    v_add_f32 v10, v10, v138
    v_add_f32 v10, v10, v139
    v_add_f32 v10, v10, v140
    v_add_f32 v10, v10, v141
    v_add_f32 v10, v10, v142
    v_add_f32 v10, v10, v143
    v_add_f32 v10, v10, v144
    v_add_f32 v10, v10, v145
    v_add_f32 v10, v10, v146
    v_add_f32 v10, v10, v147
    v_add_f32 v10, v10, v148
    v_add_f32 v10, v10, v149
    v_add_f32 v10, v10, v150
    v_add_f32 v10, v10, v151
    v_add_f32 v10, v10, v152
    v_add_f32 v10, v10, v153
    v_add_f32 v10, v10, v154
    v_add_f32 v10, v10, v155
    v_add_f32 v10, v10, v156
    v_add_f32 v10, v10, v157
    v_add_f32 v10, v10, v158
    v_add_f32 v10, v10, v159
    v_add_f32 v10, v10, v160
    v_add_f32 v10, v10, v161
    v_add_f32 v10, v10, v162
    v_add_f32 v10, v10, v163
    v_add_f32 v10, v10, v164
    v_add_f32 v10, v10, v165
    v_add_f32 v10, v10, v166
    v_add_f32 v10, v10, v167
    v_add_f32 v10, v10, v168
    v_add_f32 v10, v10, v169
    v_add_f32 v10, v10, v170
    v_add_f32 v10, v10, v171
    v_add_f32 v10, v10, v172
    v_add_f32 v10, v10, v173
    v_add_f32 v10, v10, v174
    v_add_f32 v10, v10, v175
    v_lshlrev_b32 v8, 16, v8
    v_fmac_f32 v8, v16, v9
    v_fmac_f32 v8, v20, v10
    v_cvt_pk_bf16_f32 v8, v8, v8
    global_store_short v2, v8, s[6:7]
k6_end:
    s_endpgm
.section .rodata,"a"
.p2align 6
.amdhsa_kernel k1_mod_kernel
  .amdhsa_next_free_vgpr 256
  .amdhsa_next_free_sgpr 102
  .amdhsa_accum_offset 256
  .amdhsa_group_segment_fixed_size 0
  .amdhsa_kernarg_size 112
  .amdhsa_user_sgpr_count 2
  .amdhsa_user_sgpr_kernarg_segment_ptr 1
  .amdhsa_system_sgpr_workgroup_id_x 1
.end_amdhsa_kernel
.p2align 6
.amdhsa_kernel k2_q_kernel
  .amdhsa_next_free_vgpr 256
  .amdhsa_next_free_sgpr 102
  .amdhsa_accum_offset 256
  .amdhsa_group_segment_fixed_size 0
  .amdhsa_kernarg_size 112
  .amdhsa_user_sgpr_count 2
  .amdhsa_user_sgpr_kernarg_segment_ptr 1
  .amdhsa_system_sgpr_workgroup_id_x 1
.end_amdhsa_kernel
.p2align 6
.amdhsa_kernel k3_attn_kernel
  .amdhsa_next_free_vgpr 128
  .amdhsa_next_free_sgpr 102
  .amdhsa_accum_offset 128
  .amdhsa_group_segment_fixed_size 0
  .amdhsa_kernarg_size 112
  .amdhsa_user_sgpr_count 2
  .amdhsa_user_sgpr_kernarg_segment_ptr 1
  .amdhsa_system_sgpr_workgroup_id_x 1
.end_amdhsa_kernel
.p2align 6
.amdhsa_kernel k4_wo_kernel
  .amdhsa_next_free_vgpr 256
  .amdhsa_next_free_sgpr 102
  .amdhsa_accum_offset 256
  .amdhsa_group_segment_fixed_size 0
  .amdhsa_kernarg_size 112
  .amdhsa_user_sgpr_count 2
  .amdhsa_user_sgpr_kernarg_segment_ptr 1
  .amdhsa_system_sgpr_workgroup_id_x 1
.end_amdhsa_kernel
.p2align 6
.amdhsa_kernel k4b_red_kernel
  .amdhsa_next_free_vgpr 96
  .amdhsa_next_free_sgpr 102
  .amdhsa_accum_offset 96
  .amdhsa_group_segment_fixed_size 0
  .amdhsa_kernarg_size 112
  .amdhsa_user_sgpr_count 2
  .amdhsa_user_sgpr_kernarg_segment_ptr 1
  .amdhsa_system_sgpr_workgroup_id_x 1
.end_amdhsa_kernel
.p2align 6
.amdhsa_kernel k5_ffn_kernel
  .amdhsa_next_free_vgpr 256
  .amdhsa_next_free_sgpr 102
  .amdhsa_accum_offset 256
  .amdhsa_group_segment_fixed_size 0
  .amdhsa_kernarg_size 112
  .amdhsa_user_sgpr_count 2
  .amdhsa_user_sgpr_kernarg_segment_ptr 1
  .amdhsa_system_sgpr_workgroup_id_x 1
.end_amdhsa_kernel
.p2align 6
.amdhsa_kernel k6_fin_kernel
  .amdhsa_next_free_vgpr 176
  .amdhsa_next_free_sgpr 102
  .amdhsa_accum_offset 176
  .amdhsa_group_segment_fixed_size 0
  .amdhsa_kernarg_size 112
  .amdhsa_user_sgpr_count 2
  .amdhsa_user_sgpr_kernarg_segment_ptr 1
  .amdhsa_system_sgpr_workgroup_id_x 1
.end_amdhsa_kernel
```
